```python
import torch

def _softmax(x, axis=-1):
    return torch.softmax(x, dim=axis)
def _gelu(x):
    return torch.nn.functional.gelu(x, approximate="tanh")
def _silu(x):
    return torch.nn.functional.silu(x)
def _sigmoid(x):
    return torch.sigmoid(x)
def _layernorm(x, axis=-1, eps=1e-5):
    m = x.mean(dim=axis, keepdim=True)
    v = x.var(dim=axis, keepdim=True, unbiased=False)
    return (x - m) / torch.sqrt(v + eps)
def _scatter_add(tgt, idx, src, axis=0):
    return tgt.clone().index_add_(axis, idx, src)
def _segment_sum(src, seg, n):
    out = torch.zeros((n,) + src.shape[1:], dtype=src.dtype)
    return out.index_add_(0, seg, src)
def _pad(x, pw):
    flat = tuple(v for pair in reversed(pw) for v in pair)
    return torch.nn.functional.pad(x, flat)

kernel_name = 'recurrent_scan__sliding_local_dilated__glu_gated_reglu__prompt'

def setup_inputs():

    _w = (lambda a: (lambda t: t.to(torch.bfloat16) if t.is_floating_point() else t)(torch.as_tensor(a)))
    def _A_setup():
        B, S, D = 1, 2048, 640
        return {
            "x": _w((lambda *s: torch.randn(*s, dtype=torch.bfloat16) * 0.05)(B, S, D)),
            "wqkv": _w((lambda *s: torch.randn(*s, dtype=torch.bfloat16) * 0.2)(D, 3 * D)),
            "wo": _w((lambda *s: torch.randn(*s, dtype=torch.bfloat16) * 0.2)(D, D)),
        }
    _A_in = _A_setup()

    def _B_setup():
        B, S, D, F = 1, 2048, 640, 1536
        return {
            "x": _w((lambda *s: torch.randn(*s, dtype=torch.bfloat16) * 0.05)(B, S, D)),
            "W_gate": _w((lambda *s: torch.randn(*s, dtype=torch.bfloat16) * 0.1)(D, F) * (2.0 / D) ** 0.5),
            "W_up": _w((lambda *s: torch.randn(*s, dtype=torch.bfloat16) * 0.1)(D, F) * (2.0 / D) ** 0.5),
            "W_down": _w((lambda *s: torch.randn(*s, dtype=torch.bfloat16) * 0.1)(F, D) * (1.0 / F) ** 0.5),
        }
    _B_in = _B_setup()

    return {
        "A_x": _A_in["x"],
        "A_wqkv": _A_in["wqkv"],
        "A_wo": _A_in["wo"],
        "B_x": _B_in["x"],
        "B_W_gate": _B_in["W_gate"],
        "B_W_up": _B_in["W_up"],
        "B_W_down": _B_in["W_down"],
    }

def reference(A_x, A_wqkv, A_wo, B_x, B_W_gate, B_W_up, B_W_down):
    def _A_ref(x, wqkv, wo):
        B, S, D = x.shape
        H = 32; Dh = D // H
        W, dil = 8, 2
        qkv = (lambda x, *d: x.permute(*d))((x @ wqkv).reshape(B, S, 3, H, Dh), 2, 0, 3, 1, 4)
        q, k, v = qkv[0], qkv[1], qkv[2]
        scale = Dh ** -0.5
        pos = torch.arange(S)
        off = torch.arange(W) * dil
        idx = pos[:, None] - off[None, :]
        mask = idx >= 0
        idx_c = torch.where(mask, idx, 0).reshape(-1)
        kg = k[:, :, idx_c, :].reshape(B, H, S, W, Dh)
        vg = v[:, :, idx_c, :].reshape(B, H, S, W, Dh)
        logits = torch.einsum("bhsd,bhswd->bhsw", q, kg) * scale
        logits = torch.where(mask[None, None, :, :], logits, -1e9)
        attn = _softmax(logits, axis=-1)
        o = torch.einsum("bhsw,bhswd->bhsd", attn, vg)
        return (lambda x, *d: x.permute(*d))(o, 0, 2, 1, 3).reshape(B, S, D) @ wo

    def _B_ref(x, W_gate, W_up, W_down):
        gate = torch.einsum("bsd,df->bsf", x, W_gate)
        up = torch.einsum("bsd,df->bsf", x, W_up)
        gate = gate * (lambda x, dt: x.to(dt))(gate > 0, gate.dtype)
        h = gate * up
        return torch.einsum("bsf,fd->bsd", h, W_down)

    x = A_x
    xn = _layernorm(x, axis=-1)
    s = _A_ref(xn, A_wqkv, A_wo)
    g = _silu(_B_ref(xn, B_W_gate, B_W_up, B_W_down))
    return x + s * g
```

```asm
; @launch grid=(256,1,1) block=(256,1,1) lds=163840
.amdgcn_target "amdgcn-amd-amdhsa--gfx950"
.text
.globl recurrent_scan__sliding_local_dilated__glu_gated_reglu__prompt_kernel
.p2align 8
.type recurrent_scan__sliding_local_dilated__glu_gated_reglu__prompt_kernel,@function
recurrent_scan__sliding_local_dilated__glu_gated_reglu__prompt_kernel:
    s_cmp_ge_u32 s2, 256
    s_cbranch_scc1 L_end
    s_load_dwordx16 s[16:31], s[0:1], 0
    s_load_dwordx4 s[32:35], s[0:1], 64
    s_getpc_b64 s[60:61]
L_pc:
    v_lshrrev_b32 v21, 6, v0
    v_and_b32 v20, 63, v0
    v_readfirstlane_b32 s4, v21
    v_lshlrev_b32 v1, 4, v20
    s_and_b32 s11, s2, 7
    s_lshr_b32 s10, s2, 3
    s_and_b32 s13, s10, 15
    s_lshl_b32 s13, s13, 4
    s_lshl_b32 s15, s4, 2
    s_add_u32 s13, s13, s15
    v_and_b32 v23, 3, v20
    v_add_u32 v23, s13, v23
    v_lshlrev_b32 v23, 7, v23
    v_min_u32 v23, L_code_end-L_pc-4, v23
    global_load_dword v18, v23, s[60:61]
    s_and_b32 s12, s11, 1
    s_lshl_b32 s12, s12, 3
    s_and_b32 s5, s10, 7
    s_add_u32 s5, s5, s12
    s_lshr_b32 s12, s11, 1
    s_lshl_b32 s12, s12, 2
    s_lshr_b32 s6, s10, 3
    s_add_u32 s6, s6, s12
    s_lshl_b32 s12, s11, 2
    s_and_b32 s7, s10, 3
    s_add_u32 s7, s7, s12
    s_lshr_b32 s8, s10, 2
    s_lshl_b32 s12, s5, 7
    s_lshr_b32 s13, s6, 2
    s_lshl_b32 s13, s13, 5
    s_add_u32 s12, s12, s13
    s_bfe_u32 s13, s6, 0x10001
    s_add_u32 s12, s12, s13
    s_and_b32 s13, s6, 1
    s_lshl_b32 s13, s13, 4
    s_add_u32 s12, s12, s13
    s_lshl_b32 s13, s4, 2
    s_add_u32 s12, s12, s13
    s_mul_i32 s14, s12, 1280
    v_lshrrev_b32 v21, 5, v20
    v_mul_u32_u24 v21, 2560, v21
    v_and_b32 v22, 31, v20
    v_lshl_add_u32 v21, v22, 3, v21
    v_mov_b32 v31, 0
    s_mul_i32 s13, s5, 52
    s_lshr_b32 s13, s13, 8
    s_mul_i32 s13, s13, 5
    s_sub_u32 s12, s5, s13
    s_lshl_b32 s12, s12, 1
    s_lshl_b32 s12, s12, 11
    s_sub_u32 s13, s12, 20480
    s_cmp_ge_u32 s12, 20480
    s_cselect_b32 s64, s13, s12
    s_add_u32 s12, s64, 2048
    s_sub_u32 s13, s12, 20480
    s_cmp_ge_u32 s12, 20480
    s_cselect_b32 s65, s13, s12
    s_add_u32 s12, s65, 2048
    s_sub_u32 s13, s12, 20480
    s_cmp_ge_u32 s12, 20480
    s_cselect_b32 s66, s13, s12
    s_add_u32 s12, s66, 2048
    s_sub_u32 s13, s12, 20480
    s_cmp_ge_u32 s12, 20480
    s_cselect_b32 s67, s13, s12
    s_add_u32 s12, s67, 2048
    s_sub_u32 s13, s12, 20480
    s_cmp_ge_u32 s12, 20480
    s_cselect_b32 s68, s13, s12
    s_add_u32 s12, s68, 2048
    s_sub_u32 s13, s12, 20480
    s_cmp_ge_u32 s12, 20480
    s_cselect_b32 s69, s13, s12
    s_add_u32 s12, s69, 2048
    s_sub_u32 s13, s12, 20480
    s_cmp_ge_u32 s12, 20480
    s_cselect_b32 s70, s13, s12
    s_add_u32 s12, s70, 2048
    s_sub_u32 s13, s12, 20480
    s_cmp_ge_u32 s12, 20480
    s_cselect_b32 s71, s13, s12
    s_add_u32 s12, s71, 2048
    s_sub_u32 s13, s12, 20480
    s_cmp_ge_u32 s12, 20480
    s_cselect_b32 s72, s13, s12
    s_add_u32 s12, s72, 2048
    s_sub_u32 s13, s12, 20480
    s_cmp_ge_u32 s12, 20480
    s_cselect_b32 s73, s13, s12
    s_mul_i32 s3, s4, 49152
    s_mul_i32 s12, s6, 192
    v_add_u32 v24, 0, v20
    v_mul_u32_u24 v22, 0x1556, v24
    v_lshrrev_b32 v22, 16, v22
    v_mul_u32_u24 v22, 2880, v22
    v_add3_u32 v2, s12, v22, v1
    v_add_u32 v24, 64, v20
    v_mul_u32_u24 v22, 0x1556, v24
    v_lshrrev_b32 v22, 16, v22
    v_mul_u32_u24 v25, 12, v22
    v_sub_u32 v24, v24, v25
    v_cmp_gt_u32 vcc, 2, v24
    v_mov_b32 v25, 10
    s_nop 0
    v_cndmask_b32 v24, -2, v25, vcc
    v_cmp_lt_u32 vcc, 7, v22
    v_mul_u32_u24 v22, 2880, v22
    s_nop 0
    v_cndmask_b32 v24, 0, v24, vcc
    v_lshl_add_u32 v22, v24, 4, v22
    v_add3_u32 v3, s12, v22, v1
    v_add_u32 v24, 128, v20
    v_mul_u32_u24 v22, 0x1556, v24
    v_lshrrev_b32 v22, 16, v22
    v_mul_u32_u24 v25, 12, v22
    v_sub_u32 v24, v24, v25
    v_cmp_gt_u32 vcc, 2, v24
    v_mov_b32 v25, 10
    s_nop 0
    v_cndmask_b32 v24, -2, v25, vcc
    v_cmp_lt_u32 vcc, 7, v22
    v_mul_u32_u24 v22, 2880, v22
    s_nop 0
    v_cndmask_b32 v24, 0, v24, vcc
    v_lshl_add_u32 v22, v24, 4, v22
    v_add3_u32 v4, s12, v22, v1
    s_mul_i32 s74, s4, 3072
    s_lshl_b32 s75, s4, 11
    s_lshl_b32 s82, s4, 12
    s_add_u32 s82, s82, 139264
    s_lshl_b32 s12, s10, 2
    s_add_u32 s12, s12, s4
    s_and_b32 s13, s12, 7
    s_add_u32 s15, s13, 1
    s_lshl_b32 s15, s15, 21
    s_waitcnt lgkmcnt(0)
    s_mov_b32 s36, s16
    s_and_b32 s37, s17, 0xffff
    s_mov_b32 s38, 2621440
    s_mov_b32 s39, 0x20000
    buffer_load_dwordx2 v[32:33], v21, s[36:39], s14 offen offset:0
    buffer_load_dwordx2 v[34:35], v21, s[36:39], s14 offen offset:256
    buffer_load_dwordx2 v[36:37], v21, s[36:39], s14 offen offset:512
    buffer_load_dwordx2 v[38:39], v21, s[36:39], s14 offen offset:768
    buffer_load_dwordx2 v[40:41], v21, s[36:39], s14 offen offset:1024
    s_add_u32 s100, s34, s15
    s_addc_u32 s101, s35, 0
    s_bitcmp1_b32 s12, 3
    s_cbranch_scc1 L_t2
    s_load_dword s78, s[100:101], 0
    s_branch L_t3
L_t2:
    s_cmp_eq_u32 s13, 0
    s_cselect_b64 s[100:101], s[34:35], s[100:101]
    s_cmp_eq_u32 s13, 1
    s_cselect_b64 s[100:101], s[24:25], s[100:101]
    s_cmp_eq_u32 s13, 2
    s_cselect_b64 s[100:101], s[26:27], s[100:101]
    s_cmp_eq_u32 s13, 3
    s_cselect_b64 s[100:101], s[18:19], s[100:101]
    s_cmp_eq_u32 s13, 4
    s_cselect_b32 s15, 1409020, 0
    s_cselect_b64 s[100:101], s[18:19], s[100:101]
    s_cmp_eq_u32 s13, 5
    s_cselect_b64 s[100:101], s[28:29], s[100:101]
    s_cmp_eq_u32 s13, 6
    s_cselect_b64 s[100:101], s[20:21], s[100:101]
    s_cmp_eq_u32 s13, 7
    s_cselect_b64 s[100:101], s[30:31], s[100:101]
    s_add_u32 s100, s100, s15
    s_addc_u32 s101, s101, 0
    s_cmp_eq_u32 s13, 4
    s_cselect_b32 s15, 0x100000, 0
    s_load_dword s78, s[100:101], s15
L_t3:
    s_mov_b32 s48, s34
    s_and_b32 s49, s35, 0xffff
    s_mov_b32 s50, 18874368
    s_mov_b32 s51, 0x20000
    s_mov_b32 s40, s24
    s_and_b32 s41, s25, 0xffff
    s_mov_b32 s42, 1966080
    s_mov_b32 s43, 0x20000
    s_mov_b32 s44, s26
    s_and_b32 s45, s27, 0xffff
    s_mov_b32 s46, 1966080
    s_mov_b32 s47, 0x20000
    s_barrier
    s_mul_i32 s83, s64, 96
    s_add_u32 s83, s83, s3
    s_add_u32 m0, s74, 40960
    s_nop 0
    buffer_load_dwordx4 v2, s[40:43], s83 offen offset:0 lds
    buffer_load_dwordx4 v3, s[40:43], s83 offen offset:1024 lds
    buffer_load_dwordx4 v4, s[40:43], s83 offen offset:2048 lds
    s_add_u32 m0, s74, 53248
    s_nop 0
    buffer_load_dwordx4 v2, s[44:47], s83 offen offset:0 lds
    buffer_load_dwordx4 v3, s[44:47], s83 offen offset:1024 lds
    buffer_load_dwordx4 v4, s[44:47], s83 offen offset:2048 lds
    buffer_load_dword v30, v31, s[48:51], 0 offen sc0 sc1
    s_mov_b32 s52, s30
    s_and_b32 s53, s31, 0xffff
    s_mov_b32 s54, 2621440
    s_mov_b32 s55, 0x20000
    s_mov_b32 s56, s18
    s_and_b32 s57, s19, 0xffff
    s_mov_b32 s59, 0x20000
    s_lshl_b32 s84, s4, 8
    s_add_u32 s84, s84, s2
    s_mov_b32 s32, s48
    s_mov_b32 s33, s49
    s_mov_b32 s35, 0x20000
    s_mov_b32 s94, s28
    s_mov_b32 s95, s29
    s_bfe_u32 s11, s2, 0x40003
    s_lshr_b32 s12, s84, 7
    s_lshl_b32 s12, s12, 3
    s_and_b32 s13, s2, 7
    s_add_u32 s12, s12, s13
    s_mul_i32 s13, s12, 13
    s_lshr_b32 s13, s13, 8
    s_mul_i32 s14, s13, 20
    s_sub_u32 s14, s12, s14
    s_cmp_lt_u32 s12, 60
    s_cselect_b32 s58, 2457600, 0
    s_cselect_b32 s34, 18874368, 0
    s_lshl_b32 s27, s2, 8
    s_add_u32 s27, s27, 17235968
    s_mul_i32 s24, s14, 122880
    s_mul_i32 s15, s13, 1280
    s_add_u32 s24, s24, s15
    s_mul_i32 s15, s11, 80
    s_add_u32 s24, s24, s15
    s_mul_i32 s28, s11, 20
    s_add_u32 s28, s28, s14
    s_lshl_b32 s28, s28, 13
    s_add_u32 s28, s28, 11599872
    s_lshl_b32 s15, s13, 12
    s_cmp_eq_u32 s13, 2
    s_cselect_b32 s25, 0, 2048
    s_cselect_b32 s15, 1024, s15
    s_add_u32 s25, s25, s28
    s_add_u32 s25, s25, 5120
    s_add_u32 s28, s28, s15
    v_and_b32 v185, 7, v20
    v_min_u32 v185, 4, v185
    v_lshrrev_b32 v22, 3, v20
    v_mul_u32_u24 v22, 3840, v22
    v_lshl_add_u32 v185, v185, 4, v22
    v_lshrrev_b32 v22, 4, v20
    v_lshlrev_b32 v22, 10, v22
    v_bfe_u32 v23, v20, 2, 2
    v_lshl_add_u32 v22, v23, 7, v22
    v_add_u32 v22, s82, v22
    v_and_b32 v23, 3, v20
    v_lshl_add_u32 v182, v23, 3, v22
    v_and_b32 v23, 1, v20
    v_mad_u32_u24 v183, v23, 40, v22
    v_bfe_u32 v23, v20, 3, 1
    v_add_u32 v23, s13, v23
    v_cmp_eq_u32 vcc, 1, v23
    v_mov_b32 v24, 0x40000000
    s_nop 0
    v_cndmask_b32 v184, v1, v24, vcc
    v_bfe_u32 v22, v20, 1, 4
    v_lshrrev_b32 v176, 5, v0
    v_and_b32 v23, 7, v22
    v_xor_b32 v176, v176, v23
    v_lshlrev_b32 v176, 4, v176
    v_lshl_add_u32 v176, v22, 7, v176
    v_and_b32 v23, 1, v20
    v_lshl_add_u32 v176, v23, 3, v176
    v_add_u32 v176, 0, v176
    v_lshlrev_b32 v177, 4, v0
    v_add_u32 v177, 0, v177
    s_lshl_b32 s12, s4, 5
    v_add_u32 v180, s12, v20
    v_lshlrev_b32 v178, 4, v180
    v_add_u32 v178, 8192, v178
    v_lshrrev_b32 v22, 3, v0
    v_xor_b32 v23, v22, v0
    v_and_b32 v23, 7, v23
    v_lshlrev_b32 v23, 4, v23
    v_lshl_add_u32 v179, v22, 8, v23
    v_lshrrev_b32 v22, 3, v180
    v_xor_b32 v23, v22, v180
    v_and_b32 v23, 7, v23
    v_lshlrev_b32 v23, 4, v23
    v_lshl_add_u32 v180, v22, 8, v23
    s_lshl_b32 s85, s5, 4
    s_add_u32 s85, s85, s6
    s_lshl_b32 s85, s85, 9
    s_add_u32 s85, s85, 17039360
    s_min_u32 s12, s4, 1
    s_lshl_b32 s12, s12, 30
    v_mov_b32 v28, s12
    v_lshrrev_b32 v22, 4, v20
    v_lshlrev_b32 v22, 3, v22
    v_bfe_u32 v23, v20, 2, 2
    v_add_u32 v22, v22, v23
    s_mul_i32 s11, s4, 48
    v_mul_u32_u24 v22, 192, v22
    v_bfe_u32 v24, v20, 4, 1
    v_lshlrev_b32 v24, 5, v24
    v_add_u32 v24, s11, v24
    v_and_b32 v23, 3, v20
    v_lshl_add_u32 v23, v23, 3, v24
    v_add_u32 v23, 0, v23
    v_subrev_u32 v25, 0xc0, v23
    v_min_u32 v23, v23, v25
    v_add_u32 v5, v22, v23
    v_and_b32 v23, 1, v20
    v_lshl_add_u32 v23, v23, 3, v24
    v_add_u32 v23, 32, v23
    v_subrev_u32 v25, 0xc0, v23
    v_min_u32 v23, v23, v25
    v_add_u32 v8, v22, v23
    v_bfe_u32 v23, v20, 1, 1
    v_mul_u32_u24 v23, 12288, v23
    v_add_u32 v8, v8, v23
    v_add_u32 v6, 65536, v5
    v_add_u32 v7, 114688, v5
    v_add_u32 v9, 65536, v8
    v_add_u32 v10, 114688, v8
    v_add_u32 v15, 65536, v1
    v_add_u32 v16, 131072, v1
    s_mul_i32 s15, s5, 163840
    s_mul_i32 s11, s4, 20480
    s_add_u32 s11, s15, s11
    s_add_u32 s11, s11, 65536
    v_add_u32 v11, s11, v1
    v_add_u32 v12, 81920, v11
    s_mov_b32 s60, s48
    s_mov_b32 s61, s49
    s_mov_b32 s63, 0x20000
    s_cmp_eq_u32 s5, 0
    s_cselect_b32 s62, 0, 18874368
    s_and_b32 s12, s4, 1
    s_lshl_b32 s12, s12, 10
    s_add_u32 s15, s15, s12
    s_add_u32 s15, s15, 24576
    s_lshl_b32 s10, s4, 10
    v_bfe_u32 v17, v20, 3, 1
    v_mul_u32_u24 v17, 20480, v17
    v_or_b32 v22, 128, v1
    v_add3_u32 v17, v17, v22, s15
    s_mul_i32 s11, s6, 163840
    s_lshl_b32 s15, s4, 11
    s_add_u32 s11, s11, s15
    s_add_u32 s11, s11, 11599872
    v_add_u32 v13, s11, v1
    v_add_u32 v14, 8192, v13
    v_and_b32 v22, 1, v20
    v_bfe_u32 v23, v20, 1, 1
    v_lshl_add_u32 v23, v23, 3, v22
    v_lshlrev_b32 v23, 9, v23
    s_lshl_b32 s11, s5, 13
    s_add_u32 s12, s11, s10
    s_add_u32 s12, s12, 17039360
    v_add_u32 v216, s12, v23
    s_max_u32 s11, s11, 8192
    s_add_u32 s11, s11, 17037824
    v_lshlrev_b32 v22, 10, v22
    v_add_u32 v219, s11, v22
    s_lshl_b32 s11, s6, 11
    s_add_u32 s11, s11, 17235968
    v_and_b32 v22, 7, v20
    v_bfe_u32 v23, v20, 3, 1
    v_lshl_add_u32 v22, v23, 7, v22
    v_lshl_add_u32 v217, v22, 8, s11
    s_lshr_b32 s11, s7, 1
    s_lshl_b32 s11, s11, 13
    s_add_u32 s11, s11, 17039488
    v_and_b32 v22, 15, v20
    v_lshlrev_b32 v22, 9, v22
    v_add_u32 v221, s11, v22
    s_lshl_b32 s12, s4, 11
    s_add_u32 s11, s11, s12
    s_add_u32 s11, s11, 128
    v_and_b32 v22, 3, v20
    v_lshlrev_b32 v22, 9, v22
    v_add_u32 v220, s11, v22
    s_lshl_b32 s12, s5, 3
    s_lshr_b32 s13, s6, 1
    s_add_u32 s12, s12, s13
    s_mul_i32 s12, s12, 20480
    s_and_b32 s13, s6, 1
    s_lshl_b32 s13, s13, 7
    s_add_u32 s12, s12, s13
    s_add_u32 s12, s12, 65536
    s_add_u32 s13, s12, 8192
    s_add_u32 s14, s12, 16384
    s_waitcnt vmcnt(7)
    s_add_u32 m0, s82, 0
    s_nop 0
    buffer_load_dwordx4 v185, s[56:59], s24 offen nt lds
    s_add_u32 s24, s24, 30720
    s_add_u32 m0, s82, 1024
    s_nop 0
    buffer_load_dwordx4 v185, s[56:59], s24 offen nt lds
    s_add_u32 s24, s24, 30720
    s_add_u32 m0, s82, 2048
    s_nop 0
    buffer_load_dwordx4 v185, s[56:59], s24 offen nt lds
    s_add_u32 s24, s24, 30720
    s_add_u32 m0, s82, 3072
    s_nop 0
    buffer_load_dwordx4 v185, s[56:59], s24 offen nt lds
    v_lshlrev_b32 v44, 16, v32
    v_and_b32 v45, 0xffff0000, v32
    v_lshlrev_b32 v46, 16, v33
    v_and_b32 v47, 0xffff0000, v33
    v_lshlrev_b32 v48, 16, v34
    v_and_b32 v49, 0xffff0000, v34
    v_lshlrev_b32 v50, 16, v35
    v_and_b32 v51, 0xffff0000, v35
    v_lshlrev_b32 v52, 16, v36
    v_and_b32 v53, 0xffff0000, v36
    v_lshlrev_b32 v54, 16, v37
    v_and_b32 v55, 0xffff0000, v37
    v_lshlrev_b32 v56, 16, v38
    v_and_b32 v57, 0xffff0000, v38
    v_lshlrev_b32 v58, 16, v39
    v_and_b32 v59, 0xffff0000, v39
    v_lshlrev_b32 v60, 16, v40
    v_and_b32 v61, 0xffff0000, v40
    v_lshlrev_b32 v62, 16, v41
    v_and_b32 v63, 0xffff0000, v41
    v_pk_add_f32 v[164:165], v[44:45], v[46:47]
    v_pk_add_f32 v[166:167], v[48:49], v[50:51]
    v_pk_add_f32 v[164:165], v[164:165], v[52:53]
    v_pk_add_f32 v[166:167], v[166:167], v[54:55]
    v_pk_add_f32 v[164:165], v[164:165], v[56:57]
    v_pk_add_f32 v[166:167], v[166:167], v[58:59]
    v_pk_add_f32 v[164:165], v[164:165], v[60:61]
    v_pk_add_f32 v[166:167], v[166:167], v[62:63]
    v_pk_add_f32 v[164:165], v[164:165], v[166:167]
    v_add_f32 v164, v164, v165
    s_nop 1
    v_add_f32_dpp v164, v164, v164 row_ror:8 row_mask:0xf bank_mask:0xf
    s_nop 1
    v_add_f32_dpp v164, v164, v164 row_ror:4 row_mask:0xf bank_mask:0xf
    s_nop 1
    v_add_f32_dpp v164, v164, v164 row_ror:2 row_mask:0xf bank_mask:0xf
    s_nop 1
    v_add_f32_dpp v164, v164, v164 row_ror:1 row_mask:0xf bank_mask:0xf
    v_mov_b32 v165, v164
    s_nop 1
    v_permlane16_swap_b32 v164, v165
    v_add_f32 v164, v164, v165
    v_mul_f32 v168, 0x3acccccd, v164
    v_cvt_pk_bf16_f32 v170, 0, v168
    v_pk_add_f32 v[80:81], v[44:45], v[168:169] op_sel_hi:[1,0] neg_lo:[0,1] neg_hi:[0,1]
    v_pk_add_f32 v[82:83], v[46:47], v[168:169] op_sel_hi:[1,0] neg_lo:[0,1] neg_hi:[0,1]
    v_pk_add_f32 v[84:85], v[48:49], v[168:169] op_sel_hi:[1,0] neg_lo:[0,1] neg_hi:[0,1]
    v_pk_add_f32 v[86:87], v[50:51], v[168:169] op_sel_hi:[1,0] neg_lo:[0,1] neg_hi:[0,1]
    v_pk_add_f32 v[88:89], v[52:53], v[168:169] op_sel_hi:[1,0] neg_lo:[0,1] neg_hi:[0,1]
    v_pk_add_f32 v[90:91], v[54:55], v[168:169] op_sel_hi:[1,0] neg_lo:[0,1] neg_hi:[0,1]
    v_pk_add_f32 v[92:93], v[56:57], v[168:169] op_sel_hi:[1,0] neg_lo:[0,1] neg_hi:[0,1]
    v_pk_add_f32 v[94:95], v[58:59], v[168:169] op_sel_hi:[1,0] neg_lo:[0,1] neg_hi:[0,1]
    v_pk_add_f32 v[96:97], v[60:61], v[168:169] op_sel_hi:[1,0] neg_lo:[0,1] neg_hi:[0,1]
    v_pk_add_f32 v[98:99], v[62:63], v[168:169] op_sel_hi:[1,0] neg_lo:[0,1] neg_hi:[0,1]
    v_pk_mul_f32 v[164:165], v[80:81], v[80:81]
    v_pk_mul_f32 v[166:167], v[82:83], v[82:83]
    v_pk_fma_f32 v[164:165], v[84:85], v[84:85], v[164:165]
    v_pk_fma_f32 v[166:167], v[86:87], v[86:87], v[166:167]
    v_pk_fma_f32 v[164:165], v[88:89], v[88:89], v[164:165]
    v_pk_fma_f32 v[166:167], v[90:91], v[90:91], v[166:167]
    v_pk_fma_f32 v[164:165], v[92:93], v[92:93], v[164:165]
    v_pk_fma_f32 v[166:167], v[94:95], v[94:95], v[166:167]
    v_pk_fma_f32 v[164:165], v[96:97], v[96:97], v[164:165]
    v_pk_fma_f32 v[166:167], v[98:99], v[98:99], v[166:167]
    v_pk_add_f32 v[164:165], v[164:165], v[166:167]
    v_add_f32 v164, v164, v165
    v_pk_add_f32 v[44:45], v[44:45], v[170:171] op_sel_hi:[1,0] neg_lo:[0,1] neg_hi:[0,1]
    v_pk_add_f32 v[46:47], v[46:47], v[170:171] op_sel_hi:[1,0] neg_lo:[0,1] neg_hi:[0,1]
    v_add_f32_dpp v164, v164, v164 row_ror:8 row_mask:0xf bank_mask:0xf
    v_pk_add_f32 v[48:49], v[48:49], v[170:171] op_sel_hi:[1,0] neg_lo:[0,1] neg_hi:[0,1]
    v_pk_add_f32 v[50:51], v[50:51], v[170:171] op_sel_hi:[1,0] neg_lo:[0,1] neg_hi:[0,1]
    v_add_f32_dpp v164, v164, v164 row_ror:4 row_mask:0xf bank_mask:0xf
    v_pk_add_f32 v[52:53], v[52:53], v[170:171] op_sel_hi:[1,0] neg_lo:[0,1] neg_hi:[0,1]
    v_pk_add_f32 v[54:55], v[54:55], v[170:171] op_sel_hi:[1,0] neg_lo:[0,1] neg_hi:[0,1]
    v_add_f32_dpp v164, v164, v164 row_ror:2 row_mask:0xf bank_mask:0xf
    v_pk_add_f32 v[56:57], v[56:57], v[170:171] op_sel_hi:[1,0] neg_lo:[0,1] neg_hi:[0,1]
    v_pk_add_f32 v[58:59], v[58:59], v[170:171] op_sel_hi:[1,0] neg_lo:[0,1] neg_hi:[0,1]
    v_add_f32_dpp v164, v164, v164 row_ror:1 row_mask:0xf bank_mask:0xf
    v_pk_add_f32 v[60:61], v[60:61], v[170:171] op_sel_hi:[1,0] neg_lo:[0,1] neg_hi:[0,1]
    v_pk_add_f32 v[62:63], v[62:63], v[170:171] op_sel_hi:[1,0] neg_lo:[0,1] neg_hi:[0,1]
    v_mov_b32 v165, v164
    v_cvt_pk_bf16_f32 v44, 0, v44
    v_cvt_pk_bf16_f32 v45, 0, v45
    v_permlane16_swap_b32 v164, v165
    v_add_f32 v164, v164, v165
    v_mul_f32 v164, 0x3acccccd, v164
    v_cvt_pk_bf16_f32 v164, 0, v164
    v_add_f32 v164, 0x3727c5ac, v164
    v_cvt_pk_bf16_f32 v164, 0, v164
    v_sqrt_f32 v164, v164
    v_cvt_pk_bf16_f32 v46, 0, v46
    v_cvt_pk_bf16_f32 v47, 0, v47
    v_cvt_pk_bf16_f32 v48, 0, v48
    v_cvt_pk_bf16_f32 v49, 0, v49
    v_cvt_pk_bf16_f32 v50, 0, v50
    v_cvt_pk_bf16_f32 v51, 0, v51
    v_cvt_pk_bf16_f32 v52, 0, v52
    v_cvt_pk_bf16_f32 v53, 0, v53
    v_cvt_pk_bf16_f32 v54, 0, v54
    v_cvt_pk_bf16_f32 v164, 0, v164
    v_rcp_f32 v172, v164
    v_cvt_pk_bf16_f32 v55, 0, v55
    v_cvt_pk_bf16_f32 v56, 0, v56
    v_cvt_pk_bf16_f32 v57, 0, v57
    v_cvt_pk_bf16_f32 v58, 0, v58
    v_cvt_pk_bf16_f32 v59, 0, v59
    v_cvt_pk_bf16_f32 v60, 0, v60
    v_cvt_pk_bf16_f32 v61, 0, v61
    v_cvt_pk_bf16_f32 v62, 0, v62
    v_cvt_pk_bf16_f32 v63, 0, v63
    v_pk_mul_f32 v[44:45], v[44:45], v[172:173] op_sel_hi:[1,0]
    v_pk_mul_f32 v[46:47], v[46:47], v[172:173] op_sel_hi:[1,0]
    v_cvt_pk_bf16_f32 v32, v44, v45
    v_cvt_pk_bf16_f32 v33, v46, v47
    ds_write_b64 v176, v[32:33] offset:0
    v_pk_mul_f32 v[48:49], v[48:49], v[172:173] op_sel_hi:[1,0]
    v_pk_mul_f32 v[50:51], v[50:51], v[172:173] op_sel_hi:[1,0]
    v_cvt_pk_bf16_f32 v34, v48, v49
    v_cvt_pk_bf16_f32 v35, v50, v51
    ds_write_b64 v176, v[34:35] offset:2048
    v_pk_mul_f32 v[52:53], v[52:53], v[172:173] op_sel_hi:[1,0]
    v_pk_mul_f32 v[54:55], v[54:55], v[172:173] op_sel_hi:[1,0]
    v_cvt_pk_bf16_f32 v36, v52, v53
    v_cvt_pk_bf16_f32 v37, v54, v55
    ds_write_b64 v176, v[36:37] offset:4096
    v_pk_mul_f32 v[56:57], v[56:57], v[172:173] op_sel_hi:[1,0]
    v_pk_mul_f32 v[58:59], v[58:59], v[172:173] op_sel_hi:[1,0]
    v_cvt_pk_bf16_f32 v38, v56, v57
    v_cvt_pk_bf16_f32 v39, v58, v59
    ds_write_b64 v176, v[38:39] offset:6144
    v_pk_mul_f32 v[60:61], v[60:61], v[172:173] op_sel_hi:[1,0]
    v_pk_mul_f32 v[62:63], v[62:63], v[172:173] op_sel_hi:[1,0]
    v_cvt_pk_bf16_f32 v40, v60, v61
    v_cvt_pk_bf16_f32 v41, v62, v63
    ds_write_b64 v176, v[40:41] offset:8192
    s_waitcnt lgkmcnt(0)
    s_barrier
    ds_read_b128 v[44:47], v177
    ds_read_b128 v[48:51], v177 offset:4096
    ds_read_b128 v[52:55], v178
    s_waitcnt lgkmcnt(2)
    buffer_store_dwordx4 v[44:47], v179, s[48:51], s12 offen sc0 sc1
    s_waitcnt lgkmcnt(1)
    buffer_store_dwordx4 v[48:51], v179, s[48:51], s13 offen sc0 sc1
    s_waitcnt lgkmcnt(0)
    s_mov_b32 exec_hi, 0
    buffer_store_dwordx4 v[52:55], v180, s[48:51], s14 offen sc0 sc1
    s_mov_b64 exec, -1
    s_barrier
    s_waitcnt vmcnt(7)
    v_add_u32 v30, 1, v30
    s_nop 0
    v_readfirstlane_b32 s9, v30
    s_mul_i32 s83, s65, 96
    s_add_u32 s83, s83, s3
    s_add_u32 m0, s74, 65536
    s_nop 0
    buffer_load_dwordx4 v2, s[40:43], s83 offen offset:0 lds
    buffer_load_dwordx4 v3, s[40:43], s83 offen offset:1024 lds
    buffer_load_dwordx4 v4, s[40:43], s83 offen offset:2048 lds
    s_add_u32 m0, s74, 77824
    s_nop 0
    buffer_load_dwordx4 v2, s[44:47], s83 offen offset:0 lds
    buffer_load_dwordx4 v3, s[44:47], s83 offen offset:1024 lds
    buffer_load_dwordx4 v4, s[44:47], s83 offen offset:2048 lds
    s_mov_b32 s101, s2
    s_lshl_b32 s100, s101, 8
    s_add_u32 s100, s100, 17235968
    s_mul_i32 s13, s101, 3856
    s_lshr_b32 s13, s13, 16
    s_mul_i32 s12, s13, 17
    s_sub_u32 s12, s101, s12
    s_lshl_b32 s12, s12, 2
    s_add_u32 s12, s12, s4
    s_mul_i32 s14, s12, 43
    s_lshr_b32 s14, s14, 9
    s_mul_i32 s15, s14, 12
    s_sub_u32 s15, s12, s15
    s_sub_u32 s11, s12, 48
    s_mul_i32 s29, s11, 52
    s_lshr_b32 s29, s29, 8
    s_mul_i32 s96, s29, 5
    s_sub_u32 s11, s11, s96
    s_add_u32 s11, s11, 12
    s_mov_b32 s18, 819200
    s_cmp_lt_u32 s12, 48
    s_cselect_b32 s14, s14, s29
    s_cselect_b32 s15, s15, s11
    s_cselect_b32 s16, s94, s20
    s_cselect_b32 s17, s95, s21
    s_cselect_b32 s18, 1966080, s18
    s_and_b32 s17, s17, 0xffff
    s_mov_b32 s19, 0x20000
    s_mov_b32 s20, s48
    s_mov_b32 s21, s49
    s_mov_b32 s23, 0x20000
    s_cmp_lt_u32 s101, 170
    s_cselect_b32 s18, s18, 0
    s_cselect_b32 s22, 18874368, 0
    s_mul_i32 s12, s12, 5
    s_lshl_b32 s98, s13, 2
    s_add_u32 s98, s98, 0
    s_mul_i32 s11, s98, 205
    s_lshr_b32 s11, s11, 10
    s_mul_i32 s11, s11, 335
    s_add_u32 s98, s98, s11
    s_add_u32 s98, s98, s12
    s_lshl_b32 s98, s98, 10
    s_add_u32 s98, s98, 14221312
    s_lshl_b32 s99, s13, 2
    s_add_u32 s99, s99, 1
    s_mul_i32 s11, s99, 205
    s_lshr_b32 s11, s11, 10
    s_mul_i32 s11, s11, 335
    s_add_u32 s99, s99, s11
    s_add_u32 s99, s99, s12
    s_lshl_b32 s99, s99, 10
    s_add_u32 s99, s99, 14221312
    s_lshl_b32 s0, s13, 2
    s_add_u32 s0, s0, 2
    s_mul_i32 s11, s0, 205
    s_lshr_b32 s11, s11, 10
    s_mul_i32 s11, s11, 335
    s_add_u32 s0, s0, s11
    s_add_u32 s0, s0, s12
    s_lshl_b32 s0, s0, 10
    s_add_u32 s0, s0, 14221312
    s_lshl_b32 s1, s13, 2
    s_add_u32 s1, s1, 3
    s_mul_i32 s11, s1, 205
    s_lshr_b32 s11, s11, 10
    s_mul_i32 s11, s11, 335
    s_add_u32 s1, s1, s11
    s_add_u32 s1, s1, s12
    s_lshl_b32 s1, s1, 10
    s_add_u32 s1, s1, 14221312
    s_mul_i32 s11, s15, 86
    s_lshr_b32 s11, s11, 8
    s_mul_i32 s12, s11, 3
    s_sub_u32 s12, s15, s12
    s_mul_i32 s94, s11, 96
    s_mul_i32 s11, s14, 384
    s_add_u32 s94, s94, s11
    s_mul_i32 s11, s12, s12
    s_lshl_b32 s11, s11, 2
    s_add_u32 s94, s94, s11
    s_cmp_eq_u32 s12, 2
    s_cselect_b32 s96, 4, 8
    s_mul_i32 s14, s14, 160
    s_mul_i32 s11, s15, 40
    s_sub_u32 s11, s11, 480
    s_cmp_eq_u32 s15, 16
    s_cselect_b32 s11, 16, s11
    s_cselect_b32 s12, 40, 4
    s_cselect_b32 s95, 0x50, 8
    s_mov_b32 s97, 20
    s_add_u32 s11, s11, s14
    s_cmp_lt_u32 s15, 12
    s_cselect_b32 s94, s94, s11
    s_cselect_b32 s12, 24, s12
    s_cselect_b32 s95, 48, s95
    s_cselect_b32 s96, s96, s97
    s_mul_i32 s94, s94, 1280
    s_lshl_b32 s13, s13, 7
    s_add_u32 s94, s94, s13
    s_mul_i32 s95, s95, 1280
    s_mul_i32 s96, s96, 1280
    s_add_u32 s96, s96, s94
    s_add_u32 s97, s96, s95
    s_add_u32 s95, s95, s94
    v_lshrrev_b32 v187, 5, v20
    v_mul_u32_u24 v187, s12, v187
    v_bfe_u32 v22, v20, 3, 2
    v_add_u32 v187, v187, v22
    v_mul_u32_u24 v187, 1280, v187
    v_and_b32 v22, 7, v20
    v_lshl_add_u32 v187, v22, 4, v187
    v_lshrrev_b32 v22, 2, v20
    v_lshlrev_b32 v22, 7, v22
    v_add_u32 v22, s82, v22
    v_and_b32 v23, 3, v20
    v_lshl_add_u32 v186, v23, 3, v22
    v_add_u32 v186, 0, v186
    s_mul_i32 s15, s5, 557056
    s_lshr_b32 s11, s6, 2
    s_mul_i32 s11, s11, 17408
    s_add_u32 s15, s15, s11
    s_add_u32 s15, s15, 2686976
    s_and_b32 s14, s6, 3
    s_mul_i32 s76, s14, 3072
    s_add_u32 s76, s76, s15
    s_lshl_b32 s12, s4, 8
    s_add_u32 s76, s76, s12
    s_lshl_b32 s12, s14, 10
    s_add_u32 s12, s12, s15
    s_add_u32 s12, s12, 12288
    s_lshr_b32 s13, s4, 1
    s_mul_i32 s78, s4, 69632
    s_add_u32 s78, s78, s12
    s_add_u32 s79, s78, 278528
    v_lshrrev_b32 v22, 5, v20
    v_bfe_u32 v23, v20, 4, 1
    v_and_b32 v24, 15, v20
    v_lshlrev_b32 v24, 4, v24
    v_mul_u32_u24 v25, 69632, v22
    v_add_u32 v25, v25, v24
    v_lshl_add_u32 v222, v23, 10, v25
    v_mul_u32_u24 v223, 139264, v23
    v_add_u32 v223, v223, v25
    s_mul_i32 s11, s14, 768
    s_sub_u32 s11, 4096, s11
    v_add_u32 v25, s11, v1
    v_cmp_gt_u32 vcc, 16, v20
    v_mov_b32 v21, 0x40000000
    s_nop 0
    v_cndmask_b32 v252, v21, v25, vcc
    s_mul_i32 s11, s8, 348160
    s_add_u32 s11, s11, 14221312
    s_mul_i32 s80, s4, 61440
    s_add_u32 s80, s80, s11
    s_add_u32 s11, s11, s10
    s_add_u32 s11, s11, 245760
    v_add_u32 v19, s11, v1
    s_mul_i32 s81, s7, 278528
    s_mul_i32 s12, s4, 17408
    s_add_u32 s81, s81, s12
    s_add_u32 s81, s81, 2686976
    s_add_u32 s12, s4, 0
    s_and_b32 s12, s12, 3
    s_mul_i32 s12, s12, 69632
    v_add_u32 v225, s12, v1
    s_add_u32 s12, s4, 1
    s_and_b32 s12, s12, 3
    s_mul_i32 s12, s12, 69632
    v_add_u32 v226, s12, v1
    s_add_u32 s12, s4, 2
    s_and_b32 s12, s12, 3
    s_mul_i32 s12, s12, 69632
    v_add_u32 v227, s12, v1
    s_add_u32 s12, s4, 3
    s_and_b32 s12, s12, 3
    s_mul_i32 s12, s12, 69632
    v_add_u32 v228, s12, v1
    v_add_u32 v224, 4096, v1
    s_mul_i32 s11, s8, 80
    s_lshr_b32 s11, s11, 6
    s_mul_i32 s11, s11, 4352
    s_add_u32 s11, s11, 17236096
    s_mul_i32 s12, s4, 3
    v_and_b32 v22, 7, v20
    v_cmp_gt_u32 vcc, 3, v22
    v_mov_b32 v23, s12
    v_bfe_u32 v24, v20, 3, 1
    v_cndmask_b32 v23, 9, v23, vcc
    v_mul_u32_u24 v24, 17, v24
    v_add3_u32 v22, v22, v23, v24
    v_lshl_add_u32 v218, v22, 8, s11
    v_lshlrev_b32 v24, 3, v20
    v_add_u32 v29, s10, v24
    v_add_u32 v254, 65536, v29
    v_and_b32 v22, 3, v20
    v_lshlrev_b32 v22, 7, v22
    v_bfe_u32 v23, v20, 2, 2
    v_lshl_add_u32 v22, v23, 3, v22
    s_and_b32 s12, s4, 1
    s_lshl_b32 s12, s12, 14
    s_add_u32 s13, s12, 0
    s_add_u32 s14, s12, 32768
    s_add_u32 s15, s12, 0
    s_mov_b32 s11, 65536
    s_cmp_lt_u32 s4, 2
    s_cselect_b32 s13, s13, s14
    s_cselect_b32 s11, s11, s15
    v_add_u32 v229, s13, v24
    v_add_u32 v233, s13, v22
    v_add_u32 v231, s11, v24
    v_add_u32 v250, s11, v22
    s_add_u32 s13, s12, 4096
    s_add_u32 s14, s12, 36864
    s_add_u32 s15, s12, 4096
    s_add_u32 s11, s12, 32768
    s_cmp_lt_u32 s4, 2
    s_cselect_b32 s13, s13, s14
    s_cselect_b32 s11, s11, s15
    v_add_u32 v230, s13, v24
    v_add_u32 v234, s13, v22
    v_add_u32 v232, s11, v24
    v_add_u32 v251, s11, v22
    v_cmp_gt_u32 vcc, 16, v20
    v_and_b32 v22, 15, v20
    v_lshrrev_b32 v23, 4, v20
    v_cndmask_b32 v235, 0, -1, vcc
    v_lshlrev_b32 v23, 2, v23
    v_sub_u32 v22, v22, v23
    v_mov_b32 v24, 0xf149f2ca
    s_cmp_lg_u32 s4, 0
    s_cselect_b32 s12, -9, -1
    s_cselect_b32 s13, 15, 7
    s_lshr_b32 s14, s4, 1
    s_or_b32 s14, s14, s5
    s_cselect_b32 s12, s12, -100
    v_subrev_u32 v25, 0, v22
    v_cmp_gt_u32 vcc, 8, v25
    v_cmp_ge_i32 s[30:31], -9, v25
    s_nop 0
    v_cndmask_b32 v236, v24, v31, vcc
    v_cndmask_b32 v164, 0, -1, vcc
    v_cndmask_b32 v240, v24, v31, s[30:31]
    v_cmp_ge_i32 vcc, s12, v25
    v_cmp_ge_u32 s[30:31], s13, v23
    s_nop 0
    v_cndmask_b32 v244, v24, v31, vcc
    v_cndmask_b32 v244, v24, v244, s[30:31]
    v_subrev_u32 v25, 1, v22
    v_cmp_gt_u32 vcc, 8, v25
    v_cmp_ge_i32 s[30:31], -9, v25
    s_nop 0
    v_cndmask_b32 v237, v24, v31, vcc
    v_cndmask_b32 v165, 0, -1, vcc
    v_cndmask_b32 v241, v24, v31, s[30:31]
    v_cmp_ge_i32 vcc, s12, v25
    v_cmp_ge_u32 s[30:31], s13, v23
    s_nop 0
    v_cndmask_b32 v245, v24, v31, vcc
    v_cndmask_b32 v245, v24, v245, s[30:31]
    v_subrev_u32 v25, 2, v22
    v_cmp_gt_u32 vcc, 8, v25
    v_cmp_ge_i32 s[30:31], -9, v25
    s_nop 0
    v_cndmask_b32 v238, v24, v31, vcc
    v_cndmask_b32 v166, 0, -1, vcc
    v_cndmask_b32 v242, v24, v31, s[30:31]
    v_cmp_ge_i32 vcc, s12, v25
    v_cmp_ge_u32 s[30:31], s13, v23
    s_nop 0
    v_cndmask_b32 v246, v24, v31, vcc
    v_cndmask_b32 v246, v24, v246, s[30:31]
    v_subrev_u32 v25, 3, v22
    v_cmp_gt_u32 vcc, 8, v25
    v_cmp_ge_i32 s[30:31], -9, v25
    s_nop 0
    v_cndmask_b32 v239, v24, v31, vcc
    v_cndmask_b32 v167, 0, -1, vcc
    v_cndmask_b32 v243, v24, v31, s[30:31]
    v_cmp_ge_i32 vcc, s12, v25
    v_cmp_ge_u32 s[30:31], s13, v23
    s_nop 0
    v_cndmask_b32 v247, v24, v31, vcc
    v_cndmask_b32 v247, v24, v247, s[30:31]
    s_mov_b32 s12, 0xffff
    v_bfi_b32 v248, s12, v164, v165
    v_bfi_b32 v249, s12, v166, v167
    s_waitcnt vmcnt(6)
    s_barrier
    s_mov_b64 exec, 1
    buffer_store_dword v30, v28, s[48:51], s85 offen offset:0 sc0 sc1
    s_mov_b64 exec, -1
    s_mul_i32 s83, s66, 96
    s_add_u32 s83, s83, s3
    s_add_u32 m0, s74, 90112
    s_nop 0
    buffer_load_dwordx4 v2, s[40:43], s83 offen offset:0 lds
    buffer_load_dwordx4 v3, s[40:43], s83 offen offset:1024 lds
    buffer_load_dwordx4 v4, s[40:43], s83 offen offset:2048 lds
    s_add_u32 m0, s74, 102400
    s_nop 0
    buffer_load_dwordx4 v2, s[44:47], s83 offen offset:0 lds
    buffer_load_dwordx4 v3, s[44:47], s83 offen offset:1024 lds
    buffer_load_dwordx4 v4, s[44:47], s83 offen offset:2048 lds
    s_waitcnt vmcnt(7)
    s_barrier
    ds_read_b64_tr_b16 a[0:1], v5 offset:40960
    ds_read_b64_tr_b16 a[2:3], v5 offset:41728
    ds_read_b64_tr_b16 a[4:5], v5 offset:53248
    ds_read_b64_tr_b16 a[6:7], v5 offset:54016
    ds_read_b64_tr_b16 a[8:9], v8 offset:40960
    ds_read_b64_tr_b16 a[10:11], v8 offset:41728
    ds_read_b64_tr_b16 a[12:13], v5 offset:47104
    ds_read_b64_tr_b16 a[14:15], v5 offset:47872
    ds_read_b64_tr_b16 a[16:17], v5 offset:59392
    ds_read_b64_tr_b16 a[18:19], v5 offset:60160
    ds_read_b64_tr_b16 a[20:21], v8 offset:47104
    ds_read_b64_tr_b16 a[22:23], v8 offset:47872
    ds_read_b64_tr_b16 a[24:25], v6 offset:0
    ds_read_b64_tr_b16 a[26:27], v6 offset:768
    ds_read_b64_tr_b16 a[28:29], v6 offset:12288
    ds_read_b64_tr_b16 a[30:31], v6 offset:13056
    ds_read_b64_tr_b16 a[32:33], v9 offset:0
    ds_read_b64_tr_b16 a[34:35], v9 offset:768
    ds_read_b64_tr_b16 a[36:37], v6 offset:6144
    ds_read_b64_tr_b16 a[38:39], v6 offset:6912
    ds_read_b64_tr_b16 a[40:41], v6 offset:18432
    ds_read_b64_tr_b16 a[42:43], v6 offset:19200
    ds_read_b64_tr_b16 a[44:45], v9 offset:6144
    ds_read_b64_tr_b16 a[46:47], v9 offset:6912
    ds_read_b64_tr_b16 v[128:129], v182 offset:0
    ds_read_b64_tr_b16 v[130:131], v182 offset:512
    ds_read_b64_tr_b16 v[132:133], v182 offset:40
    ds_read_b64_tr_b16 v[134:135], v182 offset:552
    ds_read_b64_tr_b16 v[136:137], v183 offset:32
    ds_read_b64_tr_b16 v[138:139], v183 offset:544
    buffer_load_dword v18, v216, s[48:51], 0 offen sc0 sc1
    s_waitcnt vmcnt(0)
    v_cmp_ne_u32 vcc, s9, v18
    s_nop 1
    s_cbranch_vccz L_pok1
    s_mov_b32 s77, 0
L_plp2:
    buffer_load_dword v18, v216, s[48:51], 0 offen sc0 sc1
    s_add_u32 s77, s77, 1
    s_waitcnt vmcnt(0)
    v_cmp_ne_u32 vcc, s9, v18
    s_nop 1
    s_cbranch_vccz L_pok1
    s_cmp_lt_u32 s77, 0x4000
    s_cbranch_scc1 L_plp2
L_pok1:
    s_add_u32 m0, s75, 0
    s_nop 0
    buffer_load_dwordx4 v11, s[48:51], s64 offen offset:0 sc1 lds
    buffer_load_dwordx4 v11, s[48:51], s64 offen offset:1024 sc1 lds
    s_add_u32 m0, s75, 8192
    s_nop 0
    buffer_load_dwordx4 v12, s[48:51], s64 offen offset:0 sc1 lds
    buffer_load_dwordx4 v12, s[48:51], s64 offen offset:1024 sc1 lds
    s_add_u32 m0, s75, 16384
    s_nop 0
    buffer_load_dwordx4 v11, s[48:51], s65 offen offset:0 sc1 lds
    buffer_load_dwordx4 v11, s[48:51], s65 offen offset:1024 sc1 lds
    s_add_u32 m0, s75, 24576
    s_nop 0
    buffer_load_dwordx4 v12, s[48:51], s65 offen offset:0 sc1 lds
    buffer_load_dwordx4 v12, s[48:51], s65 offen offset:1024 sc1 lds
    s_waitcnt vmcnt(4) lgkmcnt(0)
    s_barrier
    ds_read_b128 a[240:243], v1 offset:0
    ds_read_b128 a[244:247], v1 offset:2048
    ds_read_b128 a[248:251], v1 offset:4096
    ds_read_b128 a[252:255], v1 offset:6144
    ds_read_b128 v[200:203], v1 offset:8192
    ds_read_b128 v[204:207], v1 offset:10240
    s_waitcnt lgkmcnt(3)
    v_mfma_f32_16x16x32_bf16 v[32:35], a[0:3], a[240:243], 0
    ds_read_b128 v[208:211], v1 offset:12288
    s_mul_i32 s83, s67, 96
    v_mfma_f32_16x16x32_bf16 v[36:39], a[4:7], a[240:243], 0
    s_add_u32 s83, s83, s3
    s_add_u32 m0, s74, 114688
    v_mfma_f32_16x16x32_bf16 v[40:43], a[8:11], a[240:243], 0
    buffer_load_dwordx4 v2, s[40:43], s83 offen offset:0 lds
    v_mfma_f32_16x16x32_bf16 v[44:47], a[0:3], a[244:247], 0
    buffer_load_dwordx4 v3, s[40:43], s83 offen offset:1024 lds
    v_mfma_f32_16x16x32_bf16 v[48:51], a[4:7], a[244:247], 0
    ds_read_b64_tr_b16 a[48:49], v6 offset:24576
    ds_read_b64_tr_b16 a[50:51], v6 offset:25344
    v_mfma_f32_16x16x32_bf16 v[52:55], a[8:11], a[244:247], 0
    ds_read_b64_tr_b16 a[52:53], v6 offset:36864
    ds_read_b64_tr_b16 a[54:55], v6 offset:37632
    v_mfma_f32_16x16x32_bf16 v[56:59], a[0:3], a[248:251], 0
    ds_read_b64_tr_b16 a[56:57], v9 offset:24576
    ds_read_b64_tr_b16 a[58:59], v9 offset:25344
    v_mfma_f32_16x16x32_bf16 v[60:63], a[4:7], a[248:251], 0
    buffer_load_dwordx4 v4, s[40:43], s83 offen offset:2048 lds
    v_mfma_f32_16x16x32_bf16 v[64:67], a[8:11], a[248:251], 0
    s_add_u32 m0, s74, 126976
    s_nop 0
    buffer_load_dwordx4 v2, s[44:47], s83 offen offset:0 lds
    ds_read_b64_tr_b16 a[60:61], v6 offset:30720
    ds_read_b64_tr_b16 a[62:63], v6 offset:31488
    ds_read_b64_tr_b16 a[64:65], v6 offset:43008
    ds_read_b64_tr_b16 a[66:67], v6 offset:43776
    ds_read_b64_tr_b16 a[68:69], v9 offset:30720
    ds_read_b64_tr_b16 a[70:71], v9 offset:31488
    buffer_load_dwordx4 v3, s[44:47], s83 offen offset:1024 lds
    buffer_load_dwordx4 v4, s[44:47], s83 offen offset:2048 lds
    ds_read_b128 v[212:215], v1 offset:14336
    s_add_u32 m0, s75, 32768
    s_nop 0
    buffer_load_dwordx4 v11, s[48:51], s66 offen offset:0 sc1 lds
    buffer_load_dwordx4 v11, s[48:51], s66 offen offset:1024 sc1 lds
    s_add_u32 m0, s75, 40960
    s_nop 0
    buffer_load_dwordx4 v12, s[48:51], s66 offen offset:0 sc1 lds
    buffer_load_dwordx4 v12, s[48:51], s66 offen offset:1024 sc1 lds
    s_waitcnt lgkmcnt(1)
    v_mfma_f32_16x16x32_bf16 v[68:71], a[0:3], a[252:255], 0
    s_barrier
    ds_read_b128 a[240:243], v1 offset:1024
    v_mfma_f32_16x16x32_bf16 v[72:75], a[4:7], a[252:255], 0
    s_mul_i32 s83, s68, 96
    s_add_u32 s83, s83, s3
    v_mfma_f32_16x16x32_bf16 v[76:79], a[8:11], a[252:255], 0
    s_add_u32 m0, s74, 139264
    v_mfma_f32_16x16x32_bf16 v[80:83], a[0:3], v[200:203], 0
    buffer_load_dwordx4 v2, s[40:43], s83 offen offset:0 lds
    v_mfma_f32_16x16x32_bf16 v[84:87], a[4:7], v[200:203], 0
    ds_read_b128 a[244:247], v1 offset:3072
    v_mfma_f32_16x16x32_bf16 v[88:91], a[8:11], v[200:203], 0
    buffer_load_dwordx4 v3, s[40:43], s83 offen offset:1024 lds
    v_mfma_f32_16x16x32_bf16 v[92:95], a[0:3], v[204:207], 0
    ds_read_b128 a[248:251], v1 offset:5120
    v_mfma_f32_16x16x32_bf16 v[96:99], a[4:7], v[204:207], 0
    buffer_load_dwordx4 v4, s[40:43], s83 offen offset:2048 lds
    v_mfma_f32_16x16x32_bf16 v[100:103], a[8:11], v[204:207], 0
    ds_read_b128 a[252:255], v1 offset:7168
    s_add_u32 m0, s74, 151552
    v_mfma_f32_16x16x32_bf16 v[104:107], a[0:3], v[208:211], 0
    buffer_load_dwordx4 v2, s[44:47], s83 offen offset:0 lds
    v_mfma_f32_16x16x32_bf16 v[108:111], a[4:7], v[208:211], 0
    buffer_load_dwordx4 v3, s[44:47], s83 offen offset:1024 lds
    v_mfma_f32_16x16x32_bf16 v[112:115], a[8:11], v[208:211], 0
    ds_read_b128 v[200:203], v1 offset:9216
    buffer_load_dwordx4 v4, s[44:47], s83 offen offset:2048 lds
    s_waitcnt lgkmcnt(3)
    v_mfma_f32_16x16x32_bf16 v[116:119], a[0:3], v[212:215], 0
    ds_read_b128 v[204:207], v1 offset:11264
    v_mfma_f32_16x16x32_bf16 v[120:123], a[4:7], v[212:215], 0
    buffer_store_dwordx4 v[128:131], v1, s[32:35], s28 offen offset:0 sc0 sc1
    v_mfma_f32_16x16x32_bf16 v[124:127], a[8:11], v[212:215], 0
    ds_read_b128 v[208:211], v1 offset:13312
    v_mfma_f32_16x16x32_bf16 v[32:35], a[12:15], a[240:243], v[32:35]
    buffer_store_dwordx4 v[132:135], v1, s[32:35], s28 offen offset:2048 sc0 sc1
    v_mfma_f32_16x16x32_bf16 v[36:39], a[16:19], a[240:243], v[36:39]
    buffer_store_dwordx4 v[136:139], v184, s[32:35], s25 offen sc0 sc1
    v_mfma_f32_16x16x32_bf16 v[40:43], a[20:23], a[240:243], v[40:43]
    ds_read_b128 v[212:215], v1 offset:15360
    v_mfma_f32_16x16x32_bf16 v[44:47], a[12:15], a[244:247], v[44:47]
    v_mfma_f32_16x16x32_bf16 v[48:51], a[16:19], a[244:247], v[48:51]
    v_mfma_f32_16x16x32_bf16 v[52:55], a[20:23], a[244:247], v[52:55]
    s_waitcnt lgkmcnt(3)
    v_mfma_f32_16x16x32_bf16 v[56:59], a[12:15], a[248:251], v[56:59]
    s_waitcnt vmcnt(13)
    s_barrier
    v_mfma_f32_16x16x32_bf16 v[60:63], a[16:19], a[248:251], v[60:63]
    ds_read_b128 a[240:243], v1 offset:16384
    s_mul_i32 s83, s69, 96
    v_mfma_f32_16x16x32_bf16 v[64:67], a[20:23], a[248:251], v[64:67]
    s_add_u32 s83, s83, s3
    s_add_u32 m0, s74, 90112
    v_mfma_f32_16x16x32_bf16 v[68:71], a[12:15], a[252:255], v[68:71]
    buffer_load_dwordx4 v2, s[40:43], s83 offen offset:0 lds
    v_mfma_f32_16x16x32_bf16 v[72:75], a[16:19], a[252:255], v[72:75]
    ds_read_b64_tr_b16 a[72:73], v7 offset:0
    ds_read_b128 a[244:247], v1 offset:18432
    v_mfma_f32_16x16x32_bf16 v[76:79], a[20:23], a[252:255], v[76:79]
    ds_read_b64_tr_b16 a[74:75], v7 offset:768
    v_mfma_f32_16x16x32_bf16 v[80:83], a[12:15], v[200:203], v[80:83]
    buffer_load_dwordx4 v3, s[40:43], s83 offen offset:1024 lds
    v_mfma_f32_16x16x32_bf16 v[84:87], a[16:19], v[200:203], v[84:87]
    ds_read_b64_tr_b16 a[76:77], v7 offset:12288
    ds_read_b64_tr_b16 a[78:79], v7 offset:13056
    v_mfma_f32_16x16x32_bf16 v[88:91], a[20:23], v[200:203], v[88:91]
    ds_read_b128 a[248:251], v1 offset:20480
    buffer_load_dwordx4 v4, s[40:43], s83 offen offset:2048 lds
    ds_read_b64_tr_b16 a[80:81], v10 offset:0
    ds_read_b64_tr_b16 a[82:83], v10 offset:768
    s_add_u32 m0, s74, 102400
    s_nop 0
    buffer_load_dwordx4 v2, s[44:47], s83 offen offset:0 lds
    ds_read_b64_tr_b16 a[84:85], v7 offset:6144
    s_waitcnt lgkmcnt(10)
    v_mfma_f32_16x16x32_bf16 v[92:95], a[12:15], v[204:207], v[92:95]
    ds_read_b128 a[252:255], v1 offset:22528
    ds_read_b64_tr_b16 a[86:87], v7 offset:6912
    v_mfma_f32_16x16x32_bf16 v[96:99], a[16:19], v[204:207], v[96:99]
    buffer_load_dwordx4 v3, s[44:47], s83 offen offset:1024 lds
    v_mfma_f32_16x16x32_bf16 v[100:103], a[20:23], v[204:207], v[100:103]
    ds_read_b64_tr_b16 a[88:89], v7 offset:18432
    ds_read_b64_tr_b16 a[90:91], v7 offset:19200
    v_mfma_f32_16x16x32_bf16 v[104:107], a[12:15], v[208:211], v[104:107]
    ds_read_b128 v[200:203], v1 offset:24576
    v_mfma_f32_16x16x32_bf16 v[108:111], a[16:19], v[208:211], v[108:111]
    buffer_load_dwordx4 v4, s[44:47], s83 offen offset:2048 lds
    v_mfma_f32_16x16x32_bf16 v[112:115], a[20:23], v[208:211], v[112:115]
    ds_read_b64_tr_b16 a[92:93], v10 offset:6144
    ds_read_b64_tr_b16 a[94:95], v10 offset:6912
    v_mfma_f32_16x16x32_bf16 v[116:119], a[12:15], v[212:215], v[116:119]
    s_add_u32 m0, s75, 49152
    v_mfma_f32_16x16x32_bf16 v[120:123], a[16:19], v[212:215], v[120:123]
    buffer_load_dwordx4 v11, s[48:51], s67 offen offset:0 sc1 lds
    v_mfma_f32_16x16x32_bf16 v[124:127], a[20:23], v[212:215], v[124:127]
    ds_read_b128 v[204:207], v1 offset:26624
    buffer_load_dwordx4 v11, s[48:51], s67 offen offset:1024 sc1 lds
    s_waitcnt lgkmcnt(11)
    v_mfma_f32_16x16x32_bf16 v[32:35], a[24:27], a[240:243], v[32:35]
    ds_read_b128 v[208:211], v1 offset:28672
    s_add_u32 m0, s75, 57344
    v_mfma_f32_16x16x32_bf16 v[36:39], a[28:31], a[240:243], v[36:39]
    buffer_load_dwordx4 v12, s[48:51], s67 offen offset:0 sc1 lds
    v_mfma_f32_16x16x32_bf16 v[40:43], a[32:35], a[240:243], v[40:43]
    buffer_load_dwordx4 v12, s[48:51], s67 offen offset:1024 sc1 lds
    v_mfma_f32_16x16x32_bf16 v[44:47], a[24:27], a[244:247], v[44:47]
    ds_read_b128 v[212:215], v1 offset:30720
    v_mfma_f32_16x16x32_bf16 v[48:51], a[28:31], a[244:247], v[48:51]
    v_mfma_f32_16x16x32_bf16 v[52:55], a[32:35], a[244:247], v[52:55]
    v_mfma_f32_16x16x32_bf16 v[56:59], a[24:27], a[248:251], v[56:59]
    s_waitcnt vmcnt(13) lgkmcnt(3)
    s_barrier
    v_mfma_f32_16x16x32_bf16 v[60:63], a[28:31], a[248:251], v[60:63]
    ds_read_b128 a[240:243], v1 offset:17408
    s_mul_i32 s83, s70, 96
    v_mfma_f32_16x16x32_bf16 v[64:67], a[32:35], a[248:251], v[64:67]
    s_add_u32 s83, s83, s3
    s_add_u32 m0, s74, 114688
    v_mfma_f32_16x16x32_bf16 v[68:71], a[24:27], a[252:255], v[68:71]
    buffer_load_dwordx4 v2, s[40:43], s83 offen offset:0 lds
    v_mfma_f32_16x16x32_bf16 v[72:75], a[28:31], a[252:255], v[72:75]
    ds_read_b64_tr_b16 a[96:97], v7 offset:24576
    ds_read_b128 a[244:247], v1 offset:19456
    v_mfma_f32_16x16x32_bf16 v[76:79], a[32:35], a[252:255], v[76:79]
    ds_read_b64_tr_b16 a[98:99], v7 offset:25344
    v_mfma_f32_16x16x32_bf16 v[80:83], a[24:27], v[200:203], v[80:83]
    buffer_load_dwordx4 v3, s[40:43], s83 offen offset:1024 lds
    v_mfma_f32_16x16x32_bf16 v[84:87], a[28:31], v[200:203], v[84:87]
    ds_read_b64_tr_b16 a[100:101], v7 offset:36864
    ds_read_b64_tr_b16 a[102:103], v7 offset:37632
    v_mfma_f32_16x16x32_bf16 v[88:91], a[32:35], v[200:203], v[88:91]
    ds_read_b128 a[248:251], v1 offset:21504
    buffer_load_dwordx4 v4, s[40:43], s83 offen offset:2048 lds
    ds_read_b64_tr_b16 a[104:105], v10 offset:24576
    ds_read_b64_tr_b16 a[106:107], v10 offset:25344
    s_add_u32 m0, s74, 126976
    s_nop 0
    buffer_load_dwordx4 v2, s[44:47], s83 offen offset:0 lds
    ds_read_b64_tr_b16 a[108:109], v7 offset:30720
    s_waitcnt lgkmcnt(10)
    v_mfma_f32_16x16x32_bf16 v[92:95], a[24:27], v[204:207], v[92:95]
    ds_read_b128 a[252:255], v1 offset:23552
    ds_read_b64_tr_b16 a[110:111], v7 offset:31488
    v_mfma_f32_16x16x32_bf16 v[96:99], a[28:31], v[204:207], v[96:99]
    buffer_load_dwordx4 v3, s[44:47], s83 offen offset:1024 lds
    v_mfma_f32_16x16x32_bf16 v[100:103], a[32:35], v[204:207], v[100:103]
    ds_read_b64_tr_b16 a[112:113], v7 offset:43008
    ds_read_b64_tr_b16 a[114:115], v7 offset:43776
    v_mfma_f32_16x16x32_bf16 v[104:107], a[24:27], v[208:211], v[104:107]
    ds_read_b128 v[200:203], v1 offset:25600
    v_mfma_f32_16x16x32_bf16 v[108:111], a[28:31], v[208:211], v[108:111]
    buffer_load_dwordx4 v4, s[44:47], s83 offen offset:2048 lds
    v_mfma_f32_16x16x32_bf16 v[112:115], a[32:35], v[208:211], v[112:115]
    ds_read_b64_tr_b16 a[116:117], v10 offset:30720
    ds_read_b64_tr_b16 a[118:119], v10 offset:31488
    v_mfma_f32_16x16x32_bf16 v[116:119], a[24:27], v[212:215], v[116:119]
    s_add_u32 m0, s75, 65536
    v_mfma_f32_16x16x32_bf16 v[120:123], a[28:31], v[212:215], v[120:123]
    buffer_load_dwordx4 v11, s[48:51], s68 offen offset:0 sc1 lds
    v_mfma_f32_16x16x32_bf16 v[124:127], a[32:35], v[212:215], v[124:127]
    ds_read_b128 v[204:207], v1 offset:27648
    buffer_load_dwordx4 v11, s[48:51], s68 offen offset:1024 sc1 lds
    s_waitcnt lgkmcnt(11)
    v_mfma_f32_16x16x32_bf16 v[32:35], a[36:39], a[240:243], v[32:35]
    ds_read_b128 v[208:211], v1 offset:29696
    s_add_u32 m0, s75, 73728
    v_mfma_f32_16x16x32_bf16 v[36:39], a[40:43], a[240:243], v[36:39]
    buffer_load_dwordx4 v12, s[48:51], s68 offen offset:0 sc1 lds
    v_mfma_f32_16x16x32_bf16 v[40:43], a[44:47], a[240:243], v[40:43]
    buffer_load_dwordx4 v12, s[48:51], s68 offen offset:1024 sc1 lds
    v_mfma_f32_16x16x32_bf16 v[44:47], a[36:39], a[244:247], v[44:47]
    ds_read_b128 v[212:215], v1 offset:31744
    v_mfma_f32_16x16x32_bf16 v[48:51], a[40:43], a[244:247], v[48:51]
    v_mfma_f32_16x16x32_bf16 v[52:55], a[44:47], a[244:247], v[52:55]
    v_mfma_f32_16x16x32_bf16 v[56:59], a[36:39], a[248:251], v[56:59]
    s_waitcnt vmcnt(14) lgkmcnt(3)
    s_barrier
    v_mfma_f32_16x16x32_bf16 v[60:63], a[40:43], a[248:251], v[60:63]
    s_mov_b64 exec, 1
    buffer_store_dword v30, v28, s[48:51], s27 offen offset:0 sc0 sc1
    s_mov_b64 exec, -1
    v_mfma_f32_16x16x32_bf16 v[64:67], a[44:47], a[248:251], v[64:67]
    ds_read_b128 a[240:243], v1 offset:32768
    s_mul_i32 s83, s71, 96
    v_mfma_f32_16x16x32_bf16 v[68:71], a[36:39], a[252:255], v[68:71]
    s_add_u32 s83, s83, s3
    s_add_u32 m0, s74, 139264
    v_mfma_f32_16x16x32_bf16 v[72:75], a[40:43], a[252:255], v[72:75]
    buffer_load_dwordx4 v2, s[40:43], s83 offen offset:0 lds
    v_mfma_f32_16x16x32_bf16 v[76:79], a[44:47], a[252:255], v[76:79]
    ds_read_b64_tr_b16 a[120:121], v6 offset:24576
    ds_read_b128 a[244:247], v1 offset:34816
    v_mfma_f32_16x16x32_bf16 v[80:83], a[36:39], v[200:203], v[80:83]
    ds_read_b64_tr_b16 a[122:123], v6 offset:25344
    ds_read_b64_tr_b16 a[124:125], v6 offset:36864
    v_mfma_f32_16x16x32_bf16 v[84:87], a[40:43], v[200:203], v[84:87]
    buffer_load_dwordx4 v3, s[40:43], s83 offen offset:1024 lds
    v_mfma_f32_16x16x32_bf16 v[88:91], a[44:47], v[200:203], v[88:91]
    ds_read_b64_tr_b16 a[126:127], v6 offset:37632
    ds_read_b128 a[248:251], v1 offset:36864
    ds_read_b64_tr_b16 a[128:129], v9 offset:24576
    ds_read_b64_tr_b16 a[130:131], v9 offset:25344
    ds_read_b64_tr_b16 a[132:133], v6 offset:30720
    s_waitcnt lgkmcnt(10)
    v_mfma_f32_16x16x32_bf16 v[92:95], a[36:39], v[204:207], v[92:95]
    ds_read_b128 a[252:255], v1 offset:38912
    v_mfma_f32_16x16x32_bf16 v[96:99], a[40:43], v[204:207], v[96:99]
    buffer_load_dwordx4 v4, s[40:43], s83 offen offset:2048 lds
    v_mfma_f32_16x16x32_bf16 v[100:103], a[44:47], v[204:207], v[100:103]
    ds_read_b64_tr_b16 a[134:135], v6 offset:31488
    ds_read_b64_tr_b16 a[136:137], v6 offset:43008
    v_mfma_f32_16x16x32_bf16 v[104:107], a[36:39], v[208:211], v[104:107]
    ds_read_b64_tr_b16 a[138:139], v6 offset:43776
    ds_read_b128 v[200:203], v1 offset:40960
    v_mfma_f32_16x16x32_bf16 v[108:111], a[40:43], v[208:211], v[108:111]
    s_add_u32 m0, s74, 151552
    v_mfma_f32_16x16x32_bf16 v[112:115], a[44:47], v[208:211], v[112:115]
    buffer_load_dwordx4 v2, s[44:47], s83 offen offset:0 lds
    v_mfma_f32_16x16x32_bf16 v[116:119], a[36:39], v[212:215], v[116:119]
    ds_read_b64_tr_b16 a[140:141], v9 offset:30720
    ds_read_b64_tr_b16 a[142:143], v9 offset:31488
    v_mfma_f32_16x16x32_bf16 v[120:123], a[40:43], v[212:215], v[120:123]
    ds_read_b128 v[204:207], v1 offset:43008
    v_mfma_f32_16x16x32_bf16 v[124:127], a[44:47], v[212:215], v[124:127]
    buffer_load_dwordx4 v3, s[44:47], s83 offen offset:1024 lds
    s_waitcnt lgkmcnt(11)
    v_mfma_f32_16x16x32_bf16 v[32:35], a[48:51], a[240:243], v[32:35]
    ds_read_b128 v[208:211], v1 offset:45056
    v_mfma_f32_16x16x32_bf16 v[36:39], a[52:55], a[240:243], v[36:39]
    buffer_load_dwordx4 v4, s[44:47], s83 offen offset:2048 lds
    v_mfma_f32_16x16x32_bf16 v[40:43], a[56:59], a[240:243], v[40:43]
    ds_read_b128 v[212:215], v1 offset:47104
    v_mfma_f32_16x16x32_bf16 v[44:47], a[48:51], a[244:247], v[44:47]
    v_mfma_f32_16x16x32_bf16 v[48:51], a[52:55], a[244:247], v[48:51]
    v_mfma_f32_16x16x32_bf16 v[52:55], a[56:59], a[244:247], v[52:55]
    v_mfma_f32_16x16x32_bf16 v[56:59], a[48:51], a[248:251], v[56:59]
    s_waitcnt vmcnt(11) lgkmcnt(3)
    s_barrier
    v_mfma_f32_16x16x32_bf16 v[60:63], a[52:55], a[248:251], v[60:63]
    ds_read_b128 a[240:243], v1 offset:33792
    s_mul_i32 s83, s72, 96
    v_mfma_f32_16x16x32_bf16 v[64:67], a[56:59], a[248:251], v[64:67]
    s_add_u32 s83, s83, s3
    s_add_u32 m0, s74, 90112
    v_mfma_f32_16x16x32_bf16 v[68:71], a[48:51], a[252:255], v[68:71]
    buffer_load_dwordx4 v2, s[40:43], s83 offen offset:0 lds
    v_mfma_f32_16x16x32_bf16 v[72:75], a[52:55], a[252:255], v[72:75]
    ds_read_b64_tr_b16 a[144:145], v7 offset:0
    ds_read_b128 a[244:247], v1 offset:35840
    v_mfma_f32_16x16x32_bf16 v[76:79], a[56:59], a[252:255], v[76:79]
    ds_read_b64_tr_b16 a[146:147], v7 offset:768
    ds_read_b64_tr_b16 a[148:149], v7 offset:12288
    v_mfma_f32_16x16x32_bf16 v[80:83], a[48:51], v[200:203], v[80:83]
    buffer_load_dwordx4 v3, s[40:43], s83 offen offset:1024 lds
    v_mfma_f32_16x16x32_bf16 v[84:87], a[52:55], v[200:203], v[84:87]
    ds_read_b64_tr_b16 a[150:151], v7 offset:13056
    ds_read_b128 a[248:251], v1 offset:37888
    v_mfma_f32_16x16x32_bf16 v[88:91], a[56:59], v[200:203], v[88:91]
    ds_read_b64_tr_b16 a[152:153], v10 offset:0
    ds_read_b64_tr_b16 a[154:155], v10 offset:768
    ds_read_b64_tr_b16 a[156:157], v7 offset:6144
    s_waitcnt lgkmcnt(10)
    v_mfma_f32_16x16x32_bf16 v[92:95], a[48:51], v[204:207], v[92:95]
    ds_read_b128 a[252:255], v1 offset:39936
    v_mfma_f32_16x16x32_bf16 v[96:99], a[52:55], v[204:207], v[96:99]
    buffer_load_dwordx4 v4, s[40:43], s83 offen offset:2048 lds
    v_mfma_f32_16x16x32_bf16 v[100:103], a[56:59], v[204:207], v[100:103]
    ds_read_b64_tr_b16 a[158:159], v7 offset:6912
    ds_read_b64_tr_b16 a[160:161], v7 offset:18432
    v_mfma_f32_16x16x32_bf16 v[104:107], a[48:51], v[208:211], v[104:107]
    ds_read_b64_tr_b16 a[162:163], v7 offset:19200
    ds_read_b128 v[200:203], v1 offset:41984
    v_mfma_f32_16x16x32_bf16 v[108:111], a[52:55], v[208:211], v[108:111]
    s_add_u32 m0, s74, 102400
    v_mfma_f32_16x16x32_bf16 v[112:115], a[56:59], v[208:211], v[112:115]
    buffer_load_dwordx4 v2, s[44:47], s83 offen offset:0 lds
    v_mfma_f32_16x16x32_bf16 v[116:119], a[48:51], v[212:215], v[116:119]
    ds_read_b64_tr_b16 a[164:165], v10 offset:6144
    ds_read_b64_tr_b16 a[166:167], v10 offset:6912
    v_mfma_f32_16x16x32_bf16 v[120:123], a[52:55], v[212:215], v[120:123]
    ds_read_b128 v[204:207], v1 offset:44032
    v_mfma_f32_16x16x32_bf16 v[124:127], a[56:59], v[212:215], v[124:127]
    buffer_load_dwordx4 v3, s[44:47], s83 offen offset:1024 lds
    s_waitcnt lgkmcnt(11)
    v_mfma_f32_16x16x32_bf16 v[32:35], a[60:63], a[240:243], v[32:35]
    ds_read_b128 v[208:211], v1 offset:46080
    v_mfma_f32_16x16x32_bf16 v[36:39], a[64:67], a[240:243], v[36:39]
    buffer_load_dwordx4 v4, s[44:47], s83 offen offset:2048 lds
    v_mfma_f32_16x16x32_bf16 v[40:43], a[68:71], a[240:243], v[40:43]
    ds_read_b128 v[212:215], v1 offset:48128
    v_mfma_f32_16x16x32_bf16 v[44:47], a[60:63], a[244:247], v[44:47]
    v_mfma_f32_16x16x32_bf16 v[48:51], a[64:67], a[244:247], v[48:51]
    v_mfma_f32_16x16x32_bf16 v[52:55], a[68:71], a[244:247], v[52:55]
    v_mfma_f32_16x16x32_bf16 v[56:59], a[60:63], a[248:251], v[56:59]
    s_waitcnt vmcnt(6) lgkmcnt(3)
    s_barrier
    v_mfma_f32_16x16x32_bf16 v[60:63], a[64:67], a[248:251], v[60:63]
    ds_read_b128 a[240:243], v1 offset:49152
    s_mul_i32 s83, s73, 96
    v_mfma_f32_16x16x32_bf16 v[64:67], a[68:71], a[248:251], v[64:67]
    s_add_u32 s83, s83, s3
    s_add_u32 m0, s74, 114688
    v_mfma_f32_16x16x32_bf16 v[68:71], a[60:63], a[252:255], v[68:71]
    buffer_load_dwordx4 v2, s[40:43], s83 offen offset:0 lds
    v_mfma_f32_16x16x32_bf16 v[72:75], a[64:67], a[252:255], v[72:75]
    ds_read_b64_tr_b16 a[168:169], v7 offset:24576
    ds_read_b128 a[244:247], v1 offset:51200
    v_mfma_f32_16x16x32_bf16 v[76:79], a[68:71], a[252:255], v[76:79]
    ds_read_b64_tr_b16 a[170:171], v7 offset:25344
    ds_read_b64_tr_b16 a[172:173], v7 offset:36864
    v_mfma_f32_16x16x32_bf16 v[80:83], a[60:63], v[200:203], v[80:83]
    buffer_load_dwordx4 v3, s[40:43], s83 offen offset:1024 lds
    v_mfma_f32_16x16x32_bf16 v[84:87], a[64:67], v[200:203], v[84:87]
    ds_read_b64_tr_b16 a[174:175], v7 offset:37632
    ds_read_b128 a[248:251], v1 offset:53248
    v_mfma_f32_16x16x32_bf16 v[88:91], a[68:71], v[200:203], v[88:91]
    ds_read_b64_tr_b16 a[176:177], v10 offset:24576
    ds_read_b64_tr_b16 a[178:179], v10 offset:25344
    ds_read_b64_tr_b16 a[180:181], v7 offset:30720
    s_waitcnt lgkmcnt(10)
    v_mfma_f32_16x16x32_bf16 v[92:95], a[60:63], v[204:207], v[92:95]
    ds_read_b128 a[252:255], v1 offset:55296
    v_mfma_f32_16x16x32_bf16 v[96:99], a[64:67], v[204:207], v[96:99]
    buffer_load_dwordx4 v4, s[40:43], s83 offen offset:2048 lds
    v_mfma_f32_16x16x32_bf16 v[100:103], a[68:71], v[204:207], v[100:103]
    ds_read_b64_tr_b16 a[182:183], v7 offset:31488
    ds_read_b64_tr_b16 a[184:185], v7 offset:43008
    v_mfma_f32_16x16x32_bf16 v[104:107], a[60:63], v[208:211], v[104:107]
    ds_read_b64_tr_b16 a[186:187], v7 offset:43776
    ds_read_b128 v[200:203], v1 offset:57344
    v_mfma_f32_16x16x32_bf16 v[108:111], a[64:67], v[208:211], v[108:111]
    s_add_u32 m0, s74, 126976
    v_mfma_f32_16x16x32_bf16 v[112:115], a[68:71], v[208:211], v[112:115]
    buffer_load_dwordx4 v2, s[44:47], s83 offen offset:0 lds
    v_mfma_f32_16x16x32_bf16 v[116:119], a[60:63], v[212:215], v[116:119]
    ds_read_b64_tr_b16 a[188:189], v10 offset:30720
    ds_read_b64_tr_b16 a[190:191], v10 offset:31488
    v_mfma_f32_16x16x32_bf16 v[120:123], a[64:67], v[212:215], v[120:123]
    ds_read_b128 v[204:207], v1 offset:59392
    v_mfma_f32_16x16x32_bf16 v[124:127], a[68:71], v[212:215], v[124:127]
    buffer_load_dwordx4 v3, s[44:47], s83 offen offset:1024 lds
    s_waitcnt lgkmcnt(11)
    v_mfma_f32_16x16x32_bf16 v[32:35], a[72:75], a[240:243], v[32:35]
    ds_read_b128 v[208:211], v1 offset:61440
    v_mfma_f32_16x16x32_bf16 v[36:39], a[76:79], a[240:243], v[36:39]
    buffer_load_dwordx4 v4, s[44:47], s83 offen offset:2048 lds
    v_mfma_f32_16x16x32_bf16 v[40:43], a[80:83], a[240:243], v[40:43]
    ds_read_b128 v[212:215], v1 offset:63488
    v_mfma_f32_16x16x32_bf16 v[44:47], a[72:75], a[244:247], v[44:47]
    v_mfma_f32_16x16x32_bf16 v[48:51], a[76:79], a[244:247], v[48:51]
    v_mfma_f32_16x16x32_bf16 v[52:55], a[80:83], a[244:247], v[52:55]
    v_mfma_f32_16x16x32_bf16 v[56:59], a[72:75], a[248:251], v[56:59]
    s_waitcnt vmcnt(6) lgkmcnt(3)
    s_barrier
    v_mfma_f32_16x16x32_bf16 v[60:63], a[76:79], a[248:251], v[60:63]
    ds_read_b128 a[240:243], v1 offset:50176
    s_add_u32 m0, s82, 0
    v_mfma_f32_16x16x32_bf16 v[64:67], a[80:83], a[248:251], v[64:67]
    buffer_load_dwordx4 v187, s[16:19], s94 offen nt lds
    v_mfma_f32_16x16x32_bf16 v[68:71], a[72:75], a[252:255], v[68:71]
    ds_read_b64_tr_b16 a[192:193], v6 offset:24576
    ds_read_b128 a[244:247], v1 offset:52224
    v_mfma_f32_16x16x32_bf16 v[72:75], a[76:79], a[252:255], v[72:75]
    ds_read_b64_tr_b16 a[194:195], v6 offset:25344
    ds_read_b64_tr_b16 a[196:197], v6 offset:36864
    v_mfma_f32_16x16x32_bf16 v[76:79], a[80:83], a[252:255], v[76:79]
    ds_read_b64_tr_b16 a[198:199], v6 offset:37632
    ds_read_b128 a[248:251], v1 offset:54272
    v_mfma_f32_16x16x32_bf16 v[80:83], a[72:75], v[200:203], v[80:83]
    ds_read_b64_tr_b16 a[200:201], v9 offset:24576
    s_add_u32 m0, s82, 1024
    v_mfma_f32_16x16x32_bf16 v[84:87], a[76:79], v[200:203], v[84:87]
    buffer_load_dwordx4 v187, s[16:19], s95 offen nt lds
    v_mfma_f32_16x16x32_bf16 v[88:91], a[80:83], v[200:203], v[88:91]
    ds_read_b64_tr_b16 a[202:203], v9 offset:25344
    ds_read_b64_tr_b16 a[204:205], v6 offset:30720
    s_waitcnt lgkmcnt(10)
    v_mfma_f32_16x16x32_bf16 v[92:95], a[72:75], v[204:207], v[92:95]
    ds_read_b128 a[252:255], v1 offset:56320
    ds_read_b64_tr_b16 a[206:207], v6 offset:31488
    v_mfma_f32_16x16x32_bf16 v[96:99], a[76:79], v[204:207], v[96:99]
    ds_read_b64_tr_b16 a[208:209], v6 offset:43008
    ds_read_b64_tr_b16 a[210:211], v6 offset:43776
    v_mfma_f32_16x16x32_bf16 v[100:103], a[80:83], v[204:207], v[100:103]
    ds_read_b128 v[200:203], v1 offset:58368
    s_add_u32 m0, s82, 2048
    v_mfma_f32_16x16x32_bf16 v[104:107], a[72:75], v[208:211], v[104:107]
    buffer_load_dwordx4 v187, s[16:19], s96 offen nt lds
    v_mfma_f32_16x16x32_bf16 v[108:111], a[76:79], v[208:211], v[108:111]
    ds_read_b64_tr_b16 a[212:213], v9 offset:30720
    ds_read_b64_tr_b16 a[214:215], v9 offset:31488
    v_mfma_f32_16x16x32_bf16 v[112:115], a[80:83], v[208:211], v[112:115]
    ds_read_b128 v[204:207], v1 offset:60416
    v_mfma_f32_16x16x32_bf16 v[116:119], a[72:75], v[212:215], v[116:119]
    s_add_u32 m0, s82, 3072
    v_mfma_f32_16x16x32_bf16 v[120:123], a[76:79], v[212:215], v[120:123]
    buffer_load_dwordx4 v187, s[16:19], s97 offen nt lds
    v_mfma_f32_16x16x32_bf16 v[124:127], a[80:83], v[212:215], v[124:127]
    s_waitcnt lgkmcnt(11)
    ds_read_b128 v[208:211], v1 offset:62464
    v_mfma_f32_16x16x32_bf16 v[32:35], a[84:87], a[240:243], v[32:35]
    v_mfma_f32_16x16x32_bf16 v[36:39], a[88:91], a[240:243], v[36:39]
    ds_read_b128 v[212:215], v1 offset:64512
    v_mfma_f32_16x16x32_bf16 v[40:43], a[92:95], a[240:243], v[40:43]
    v_mfma_f32_16x16x32_bf16 v[44:47], a[84:87], a[244:247], v[44:47]
    v_mfma_f32_16x16x32_bf16 v[48:51], a[88:91], a[244:247], v[48:51]
    v_mfma_f32_16x16x32_bf16 v[52:55], a[92:95], a[244:247], v[52:55]
    v_mfma_f32_16x16x32_bf16 v[56:59], a[84:87], a[248:251], v[56:59]
    s_waitcnt vmcnt(4) lgkmcnt(3)
    s_barrier
    v_mfma_f32_16x16x32_bf16 v[60:63], a[88:91], a[248:251], v[60:63]
    ds_read_b128 a[240:243], v15 offset:0
    s_add_u32 m0, s75, 81920
    v_mfma_f32_16x16x32_bf16 v[64:67], a[92:95], a[248:251], v[64:67]
    buffer_load_dwordx4 v11, s[48:51], s69 offen offset:0 sc1 lds
    v_mfma_f32_16x16x32_bf16 v[68:71], a[84:87], a[252:255], v[68:71]
    ds_read_b64_tr_b16 a[216:217], v7 offset:0
    ds_read_b128 a[244:247], v15 offset:2048
    v_mfma_f32_16x16x32_bf16 v[72:75], a[88:91], a[252:255], v[72:75]
    ds_read_b64_tr_b16 a[218:219], v7 offset:768
    v_mfma_f32_16x16x32_bf16 v[76:79], a[92:95], a[252:255], v[76:79]
    buffer_load_dwordx4 v11, s[48:51], s69 offen offset:1024 sc1 lds
    v_mfma_f32_16x16x32_bf16 v[80:83], a[84:87], v[200:203], v[80:83]
    ds_read_b64_tr_b16 a[220:221], v7 offset:12288
    ds_read_b64_tr_b16 a[222:223], v7 offset:13056
    v_mfma_f32_16x16x32_bf16 v[84:87], a[88:91], v[200:203], v[84:87]
    ds_read_b128 a[248:251], v15 offset:4096
    ds_read_b64_tr_b16 a[224:225], v10 offset:0
    v_mfma_f32_16x16x32_bf16 v[88:91], a[92:95], v[200:203], v[88:91]
    s_add_u32 m0, s75, 90112
    s_nop 0
    buffer_load_dwordx4 v12, s[48:51], s69 offen offset:0 sc1 lds
    ds_read_b64_tr_b16 a[226:227], v10 offset:768
    ds_read_b64_tr_b16 a[228:229], v7 offset:6144
    s_waitcnt lgkmcnt(10)
    v_mfma_f32_16x16x32_bf16 v[92:95], a[84:87], v[204:207], v[92:95]
    ds_read_b128 a[252:255], v15 offset:6144
    v_mfma_f32_16x16x32_bf16 v[96:99], a[88:91], v[204:207], v[96:99]
    buffer_load_dwordx4 v12, s[48:51], s69 offen offset:1024 sc1 lds
    v_mfma_f32_16x16x32_bf16 v[100:103], a[92:95], v[204:207], v[100:103]
    ds_read_b64_tr_b16 a[230:231], v7 offset:6912
    ds_read_b64_tr_b16 a[232:233], v7 offset:18432
    v_mfma_f32_16x16x32_bf16 v[104:107], a[84:87], v[208:211], v[104:107]
    ds_read_b64_tr_b16 a[234:235], v7 offset:19200
    ds_read_b128 v[200:203], v15 offset:8192
    v_mfma_f32_16x16x32_bf16 v[108:111], a[88:91], v[208:211], v[108:111]
    s_add_u32 m0, s75, 98304
    v_mfma_f32_16x16x32_bf16 v[112:115], a[92:95], v[208:211], v[112:115]
    buffer_load_dwordx4 v11, s[48:51], s70 offen offset:0 sc1 lds
    v_mfma_f32_16x16x32_bf16 v[116:119], a[84:87], v[212:215], v[116:119]
    ds_read_b64_tr_b16 a[236:237], v10 offset:6144
    ds_read_b64_tr_b16 a[238:239], v10 offset:6912
    v_mfma_f32_16x16x32_bf16 v[120:123], a[88:91], v[212:215], v[120:123]
    ds_read_b128 v[204:207], v15 offset:10240
    v_mfma_f32_16x16x32_bf16 v[124:127], a[92:95], v[212:215], v[124:127]
    buffer_load_dwordx4 v11, s[48:51], s70 offen offset:1024 sc1 lds
    s_add_u32 m0, s75, 106496
    s_nop 0
    buffer_load_dwordx4 v12, s[48:51], s70 offen offset:0 sc1 lds
    s_waitcnt lgkmcnt(11)
    v_mfma_f32_16x16x32_bf16 v[32:35], a[96:99], a[240:243], v[32:35]
    ds_read_b128 v[208:211], v15 offset:12288
    v_mfma_f32_16x16x32_bf16 v[36:39], a[100:103], a[240:243], v[36:39]
    buffer_load_dwordx4 v12, s[48:51], s70 offen offset:1024 sc1 lds
    v_mfma_f32_16x16x32_bf16 v[40:43], a[104:107], a[240:243], v[40:43]
    ds_read_b128 v[212:215], v15 offset:14336
    v_mfma_f32_16x16x32_bf16 v[44:47], a[96:99], a[244:247], v[44:47]
    v_mfma_f32_16x16x32_bf16 v[48:51], a[100:103], a[244:247], v[48:51]
    v_mfma_f32_16x16x32_bf16 v[52:55], a[104:107], a[244:247], v[52:55]
    v_mfma_f32_16x16x32_bf16 v[56:59], a[96:99], a[248:251], v[56:59]
    s_waitcnt lgkmcnt(3)
    s_barrier
    v_mfma_f32_16x16x32_bf16 v[60:63], a[100:103], a[248:251], v[60:63]
    ds_read_b128 a[240:243], v15 offset:1024
    s_add_u32 m0, s75, 114688
    v_mfma_f32_16x16x32_bf16 v[64:67], a[104:107], a[248:251], v[64:67]
    buffer_load_dwordx4 v11, s[48:51], s71 offen offset:0 sc1 lds
    v_mfma_f32_16x16x32_bf16 v[68:71], a[96:99], a[252:255], v[68:71]
    ds_read_b128 a[244:247], v15 offset:3072
    v_mfma_f32_16x16x32_bf16 v[72:75], a[100:103], a[252:255], v[72:75]
    ds_read_b128 a[248:251], v15 offset:5120
    v_mfma_f32_16x16x32_bf16 v[76:79], a[104:107], a[252:255], v[76:79]
    buffer_load_dwordx4 v11, s[48:51], s71 offen offset:1024 sc1 lds
    v_mfma_f32_16x16x32_bf16 v[80:83], a[96:99], v[200:203], v[80:83]
    v_mfma_f32_16x16x32_bf16 v[84:87], a[100:103], v[200:203], v[84:87]
    v_mfma_f32_16x16x32_bf16 v[88:91], a[104:107], v[200:203], v[88:91]
    s_waitcnt lgkmcnt(3)
    ds_read_b128 a[252:255], v15 offset:7168
    v_mfma_f32_16x16x32_bf16 v[92:95], a[96:99], v[204:207], v[92:95]
    v_mfma_f32_16x16x32_bf16 v[96:99], a[100:103], v[204:207], v[96:99]
    ds_read_b128 v[200:203], v15 offset:9216
    s_add_u32 m0, s75, 122880
    v_mfma_f32_16x16x32_bf16 v[100:103], a[104:107], v[204:207], v[100:103]
    buffer_load_dwordx4 v12, s[48:51], s71 offen offset:0 sc1 lds
    v_mfma_f32_16x16x32_bf16 v[104:107], a[96:99], v[208:211], v[104:107]
    v_mfma_f32_16x16x32_bf16 v[108:111], a[100:103], v[208:211], v[108:111]
    ds_read_b128 v[204:207], v15 offset:11264
    v_mfma_f32_16x16x32_bf16 v[112:115], a[104:107], v[208:211], v[112:115]
    v_mfma_f32_16x16x32_bf16 v[116:119], a[96:99], v[212:215], v[116:119]
    buffer_load_dwordx4 v12, s[48:51], s71 offen offset:1024 sc1 lds
    v_mfma_f32_16x16x32_bf16 v[120:123], a[100:103], v[212:215], v[120:123]
    v_mfma_f32_16x16x32_bf16 v[124:127], a[104:107], v[212:215], v[124:127]
    s_waitcnt lgkmcnt(3)
    ds_read_b128 v[208:211], v15 offset:13312
    v_mfma_f32_16x16x32_bf16 v[32:35], a[108:111], a[240:243], v[32:35]
    v_mfma_f32_16x16x32_bf16 v[36:39], a[112:115], a[240:243], v[36:39]
    ds_read_b128 v[212:215], v15 offset:15360
    v_mfma_f32_16x16x32_bf16 v[40:43], a[116:119], a[240:243], v[40:43]
    v_mfma_f32_16x16x32_bf16 v[44:47], a[108:111], a[244:247], v[44:47]
    v_mfma_f32_16x16x32_bf16 v[48:51], a[112:115], a[244:247], v[48:51]
    v_mfma_f32_16x16x32_bf16 v[52:55], a[116:119], a[244:247], v[52:55]
    v_mfma_f32_16x16x32_bf16 v[56:59], a[108:111], a[248:251], v[56:59]
    s_waitcnt vmcnt(4)
    s_barrier
    v_mfma_f32_16x16x32_bf16 v[60:63], a[112:115], a[248:251], v[60:63]
    ds_read_b128 a[240:243], v15 offset:16384
    v_mfma_f32_16x16x32_bf16 v[64:67], a[116:119], a[248:251], v[64:67]
    s_waitcnt lgkmcnt(3)
    ds_read_b128 a[244:247], v15 offset:18432
    v_mfma_f32_16x16x32_bf16 v[68:71], a[108:111], a[252:255], v[68:71]
    v_mfma_f32_16x16x32_bf16 v[72:75], a[112:115], a[252:255], v[72:75]
    ds_read_b128 a[248:251], v15 offset:20480
    v_mfma_f32_16x16x32_bf16 v[76:79], a[116:119], a[252:255], v[76:79]
    v_mfma_f32_16x16x32_bf16 v[80:83], a[108:111], v[200:203], v[80:83]
    v_mfma_f32_16x16x32_bf16 v[84:87], a[112:115], v[200:203], v[84:87]
    ds_read_b128 a[252:255], v15 offset:22528
    v_mfma_f32_16x16x32_bf16 v[88:91], a[116:119], v[200:203], v[88:91]
    v_mfma_f32_16x16x32_bf16 v[92:95], a[108:111], v[204:207], v[92:95]
    v_mfma_f32_16x16x32_bf16 v[96:99], a[112:115], v[204:207], v[96:99]
    v_mfma_f32_16x16x32_bf16 v[100:103], a[116:119], v[204:207], v[100:103]
    s_waitcnt lgkmcnt(3)
    ds_read_b128 v[200:203], v15 offset:24576
    v_mfma_f32_16x16x32_bf16 v[104:107], a[108:111], v[208:211], v[104:107]
    v_mfma_f32_16x16x32_bf16 v[108:111], a[112:115], v[208:211], v[108:111]
    ds_read_b128 v[204:207], v15 offset:26624
    v_mfma_f32_16x16x32_bf16 v[112:115], a[116:119], v[208:211], v[112:115]
    v_mfma_f32_16x16x32_bf16 v[116:119], a[108:111], v[212:215], v[116:119]
    v_mfma_f32_16x16x32_bf16 v[120:123], a[112:115], v[212:215], v[120:123]
    ds_read_b128 v[208:211], v15 offset:28672
    v_mfma_f32_16x16x32_bf16 v[124:127], a[116:119], v[212:215], v[124:127]
    v_mfma_f32_16x16x32_bf16 v[32:35], a[120:123], a[240:243], v[32:35]
    v_mfma_f32_16x16x32_bf16 v[36:39], a[124:127], a[240:243], v[36:39]
    v_mfma_f32_16x16x32_bf16 v[40:43], a[128:131], a[240:243], v[40:43]
    s_waitcnt lgkmcnt(3)
    ds_read_b128 v[212:215], v15 offset:30720
    v_mfma_f32_16x16x32_bf16 v[44:47], a[120:123], a[244:247], v[44:47]
    v_mfma_f32_16x16x32_bf16 v[48:51], a[124:127], a[244:247], v[48:51]
    v_mfma_f32_16x16x32_bf16 v[52:55], a[128:131], a[244:247], v[52:55]
    v_mfma_f32_16x16x32_bf16 v[56:59], a[120:123], a[248:251], v[56:59]
    s_barrier
    ds_read_b128 a[240:243], v15 offset:17408
    v_mfma_f32_16x16x32_bf16 v[60:63], a[124:127], a[248:251], v[60:63]
    ds_read_b64_tr_b16 v[144:145], v186 offset:0
    ds_read_b64_tr_b16 v[146:147], v186 offset:2048
    v_mfma_f32_16x16x32_bf16 v[64:67], a[128:131], a[248:251], v[64:67]
    ds_read_b128 a[244:247], v15 offset:19456
    ds_read_b64_tr_b16 v[148:149], v186 offset:32
    v_mfma_f32_16x16x32_bf16 v[68:71], a[120:123], a[252:255], v[68:71]
    ds_read_b64_tr_b16 v[150:151], v186 offset:2080
    v_mfma_f32_16x16x32_bf16 v[72:75], a[124:127], a[252:255], v[72:75]
    buffer_load_dword v18, v217, s[48:51], 0 offen sc0 sc1
    v_mfma_f32_16x16x32_bf16 v[76:79], a[128:131], a[252:255], v[76:79]
    s_waitcnt lgkmcnt(7)
    ds_read_b128 a[248:251], v15 offset:21504
    v_mfma_f32_16x16x32_bf16 v[80:83], a[120:123], v[200:203], v[80:83]
    ds_read_b64_tr_b16 v[152:153], v186 offset:64
    ds_read_b64_tr_b16 v[154:155], v186 offset:2112
    v_mfma_f32_16x16x32_bf16 v[84:87], a[124:127], v[200:203], v[84:87]
    ds_read_b128 a[252:255], v15 offset:23552
    ds_read_b64_tr_b16 v[156:157], v186 offset:96
    v_mfma_f32_16x16x32_bf16 v[88:91], a[128:131], v[200:203], v[88:91]
    ds_read_b64_tr_b16 v[158:159], v186 offset:2144
    v_mfma_f32_16x16x32_bf16 v[92:95], a[120:123], v[204:207], v[92:95]
    v_mfma_f32_16x16x32_bf16 v[96:99], a[124:127], v[204:207], v[96:99]
    ds_read_b128 v[200:203], v15 offset:25600
    v_mfma_f32_16x16x32_bf16 v[100:103], a[128:131], v[204:207], v[100:103]
    v_mfma_f32_16x16x32_bf16 v[104:107], a[120:123], v[208:211], v[104:107]
    s_waitcnt lgkmcnt(10)
    v_mfma_f32_16x16x32_bf16 v[108:111], a[124:127], v[208:211], v[108:111]
    buffer_store_dwordx4 v[144:147], v1, s[20:23], s98 offen sc0 sc1
    v_mfma_f32_16x16x32_bf16 v[112:115], a[128:131], v[208:211], v[112:115]
    ds_read_b128 v[204:207], v15 offset:27648
    v_mfma_f32_16x16x32_bf16 v[116:119], a[120:123], v[212:215], v[116:119]
    s_waitcnt lgkmcnt(8)
    v_mfma_f32_16x16x32_bf16 v[120:123], a[124:127], v[212:215], v[120:123]
    buffer_store_dwordx4 v[148:151], v1, s[20:23], s99 offen sc0 sc1
    v_mfma_f32_16x16x32_bf16 v[124:127], a[128:131], v[212:215], v[124:127]
    s_waitcnt lgkmcnt(5)
    v_mfma_f32_16x16x32_bf16 v[32:35], a[132:135], a[240:243], v[32:35]
    buffer_store_dwordx4 v[152:155], v1, s[20:23], s0 offen sc0 sc1
    v_mfma_f32_16x16x32_bf16 v[36:39], a[136:139], a[240:243], v[36:39]
    ds_read_b128 v[208:211], v15 offset:29696
    v_mfma_f32_16x16x32_bf16 v[40:43], a[140:143], a[240:243], v[40:43]
    s_waitcnt lgkmcnt(3)
    v_mfma_f32_16x16x32_bf16 v[44:47], a[132:135], a[244:247], v[44:47]
    buffer_store_dwordx4 v[156:159], v1, s[20:23], s1 offen sc0 sc1
    v_mfma_f32_16x16x32_bf16 v[48:51], a[136:139], a[244:247], v[48:51]
    ds_read_b128 v[212:215], v15 offset:31744
    v_mfma_f32_16x16x32_bf16 v[52:55], a[140:143], a[244:247], v[52:55]
    v_mfma_f32_16x16x32_bf16 v[56:59], a[132:135], a[248:251], v[56:59]
    s_barrier
    ds_read_b128 a[240:243], v15 offset:32768
    v_mfma_f32_16x16x32_bf16 v[60:63], a[136:139], a[248:251], v[60:63]
    s_add_u32 m0, s75, 131072
    v_mfma_f32_16x16x32_bf16 v[64:67], a[140:143], a[248:251], v[64:67]
    buffer_load_dwordx4 v11, s[48:51], s72 offen offset:0 sc1 lds
    v_mfma_f32_16x16x32_bf16 v[68:71], a[132:135], a[252:255], v[68:71]
    ds_read_b128 a[244:247], v15 offset:34816
    v_mfma_f32_16x16x32_bf16 v[72:75], a[136:139], a[252:255], v[72:75]
    v_mfma_f32_16x16x32_bf16 v[76:79], a[140:143], a[252:255], v[76:79]
    s_waitcnt lgkmcnt(3)
    ds_read_b128 a[248:251], v15 offset:36864
    v_mfma_f32_16x16x32_bf16 v[80:83], a[132:135], v[200:203], v[80:83]
    buffer_load_dwordx4 v11, s[48:51], s72 offen offset:1024 sc1 lds
    v_mfma_f32_16x16x32_bf16 v[84:87], a[136:139], v[200:203], v[84:87]
    ds_read_b128 a[252:255], v15 offset:38912
    v_mfma_f32_16x16x32_bf16 v[88:91], a[140:143], v[200:203], v[88:91]
    v_mfma_f32_16x16x32_bf16 v[92:95], a[132:135], v[204:207], v[92:95]
    v_mfma_f32_16x16x32_bf16 v[96:99], a[136:139], v[204:207], v[96:99]
    ds_read_b128 v[200:203], v15 offset:40960
    v_mfma_f32_16x16x32_bf16 v[100:103], a[140:143], v[204:207], v[100:103]
    s_add_u32 m0, s75, 139264
    v_mfma_f32_16x16x32_bf16 v[104:107], a[132:135], v[208:211], v[104:107]
    buffer_load_dwordx4 v12, s[48:51], s72 offen offset:0 sc1 lds
    v_mfma_f32_16x16x32_bf16 v[108:111], a[136:139], v[208:211], v[108:111]
    v_mfma_f32_16x16x32_bf16 v[112:115], a[140:143], v[208:211], v[112:115]
    s_waitcnt lgkmcnt(3)
    ds_read_b128 v[204:207], v15 offset:43008
    v_mfma_f32_16x16x32_bf16 v[116:119], a[132:135], v[212:215], v[116:119]
    v_mfma_f32_16x16x32_bf16 v[120:123], a[136:139], v[212:215], v[120:123]
    ds_read_b128 v[208:211], v15 offset:45056
    v_mfma_f32_16x16x32_bf16 v[124:127], a[140:143], v[212:215], v[124:127]
    buffer_load_dwordx4 v12, s[48:51], s72 offen offset:1024 sc1 lds
    v_mfma_f32_16x16x32_bf16 v[32:35], a[144:147], a[240:243], v[32:35]
    v_mfma_f32_16x16x32_bf16 v[36:39], a[148:151], a[240:243], v[36:39]
    ds_read_b128 v[212:215], v15 offset:47104
    v_mfma_f32_16x16x32_bf16 v[40:43], a[152:155], a[240:243], v[40:43]
    v_mfma_f32_16x16x32_bf16 v[44:47], a[144:147], a[244:247], v[44:47]
    v_mfma_f32_16x16x32_bf16 v[48:51], a[148:151], a[244:247], v[48:51]
    v_mfma_f32_16x16x32_bf16 v[52:55], a[152:155], a[244:247], v[52:55]
    s_waitcnt lgkmcnt(3)
    ds_read_b128 a[240:243], v15 offset:33792
    v_mfma_f32_16x16x32_bf16 v[56:59], a[144:147], a[248:251], v[56:59]
    s_add_u32 m0, s75, 147456
    v_mfma_f32_16x16x32_bf16 v[60:63], a[148:151], a[248:251], v[60:63]
    buffer_load_dwordx4 v11, s[48:51], s73 offen offset:0 sc1 lds
    v_mfma_f32_16x16x32_bf16 v[64:67], a[152:155], a[248:251], v[64:67]
    ds_read_b128 a[244:247], v15 offset:35840
    v_mfma_f32_16x16x32_bf16 v[68:71], a[144:147], a[252:255], v[68:71]
    v_mfma_f32_16x16x32_bf16 v[72:75], a[148:151], a[252:255], v[72:75]
    v_mfma_f32_16x16x32_bf16 v[76:79], a[152:155], a[252:255], v[76:79]
    s_waitcnt vmcnt(9)
    v_cmp_ne_u32 vcc, s9, v18
    v_mfma_f32_16x16x32_bf16 v[80:83], a[144:147], v[200:203], v[80:83]
    v_mfma_f32_16x16x32_bf16 v[84:87], a[148:151], v[200:203], v[84:87]
    s_cbranch_vccnz L_plp4
L_pok3:
    ds_read_b128 a[248:251], v15 offset:37888
    v_mfma_f32_16x16x32_bf16 v[88:91], a[152:155], v[200:203], v[88:91]
    buffer_load_dwordx4 v11, s[48:51], s73 offen offset:1024 sc1 lds
    s_lshl_b32 s84, s64, 3
    buffer_load_dwordx4 a[0:3], v13, s[48:51], s84 offen offset:0 sc1
    s_waitcnt lgkmcnt(3)
    v_mfma_f32_16x16x32_bf16 v[92:95], a[144:147], v[204:207], v[92:95]
    ds_read_b128 a[252:255], v15 offset:39936
    v_mfma_f32_16x16x32_bf16 v[96:99], a[148:151], v[204:207], v[96:99]
    buffer_load_dwordx4 a[4:7], v13, s[48:51], s84 offen offset:1024 sc1
    v_mfma_f32_16x16x32_bf16 v[100:103], a[152:155], v[204:207], v[100:103]
    s_add_u32 m0, s75, 155648
    v_mfma_f32_16x16x32_bf16 v[104:107], a[144:147], v[208:211], v[104:107]
    buffer_load_dwordx4 v12, s[48:51], s73 offen offset:0 sc1 lds
    v_mfma_f32_16x16x32_bf16 v[108:111], a[148:151], v[208:211], v[108:111]
    ds_read_b128 v[200:203], v15 offset:41984
    v_mfma_f32_16x16x32_bf16 v[112:115], a[152:155], v[208:211], v[112:115]
    buffer_load_dwordx4 a[8:11], v14, s[48:51], s84 offen offset:0 sc1
    v_mfma_f32_16x16x32_bf16 v[116:119], a[144:147], v[212:215], v[116:119]
    ds_read_b128 v[204:207], v15 offset:44032
    v_mfma_f32_16x16x32_bf16 v[120:123], a[148:151], v[212:215], v[120:123]
    buffer_load_dwordx4 v12, s[48:51], s73 offen offset:1024 sc1 lds
    v_mfma_f32_16x16x32_bf16 v[124:127], a[152:155], v[212:215], v[124:127]
    s_waitcnt lgkmcnt(3)
    ds_read_b128 v[208:211], v15 offset:46080
    v_mfma_f32_16x16x32_bf16 v[32:35], a[156:159], a[240:243], v[32:35]
    buffer_load_dwordx4 a[12:15], v14, s[48:51], s84 offen offset:1024 sc1
    v_mfma_f32_16x16x32_bf16 v[36:39], a[160:163], a[240:243], v[36:39]
    ds_read_b128 v[212:215], v15 offset:48128
    v_mfma_f32_16x16x32_bf16 v[40:43], a[164:167], a[240:243], v[40:43]
    v_mfma_f32_16x16x32_bf16 v[44:47], a[156:159], a[244:247], v[44:47]
    s_lshl_b32 s84, s65, 3
    v_mfma_f32_16x16x32_bf16 v[48:51], a[160:163], a[244:247], v[48:51]
    buffer_load_dwordx4 a[16:19], v13, s[48:51], s84 offen offset:0 sc1
    v_mfma_f32_16x16x32_bf16 v[52:55], a[164:167], a[244:247], v[52:55]
    v_mfma_f32_16x16x32_bf16 v[56:59], a[156:159], a[248:251], v[56:59]
    s_waitcnt vmcnt(13)
    s_barrier
    v_mfma_f32_16x16x32_bf16 v[60:63], a[160:163], a[248:251], v[60:63]
    s_mov_b64 exec, 1
    buffer_store_dword v30, v28, s[48:51], s100 offen offset:128 sc0 sc1
    s_mov_b64 exec, -1
    v_mfma_f32_16x16x32_bf16 v[64:67], a[164:167], a[248:251], v[64:67]
    ds_read_b128 a[240:243], v15 offset:49152
    s_waitcnt lgkmcnt(3)
    v_mfma_f32_16x16x32_bf16 v[68:71], a[156:159], a[252:255], v[68:71]
    ds_read_b128 a[244:247], v15 offset:51200
    v_mfma_f32_16x16x32_bf16 v[72:75], a[160:163], a[252:255], v[72:75]
    buffer_load_dwordx4 a[20:23], v13, s[48:51], s84 offen offset:1024 sc1
    v_mfma_f32_16x16x32_bf16 v[76:79], a[164:167], a[252:255], v[76:79]
    ds_read_b128 a[248:251], v15 offset:53248
    v_mfma_f32_16x16x32_bf16 v[80:83], a[156:159], v[200:203], v[80:83]
    buffer_load_dwordx4 a[24:27], v14, s[48:51], s84 offen offset:0 sc1
    v_mfma_f32_16x16x32_bf16 v[84:87], a[160:163], v[200:203], v[84:87]
    ds_read_b128 a[252:255], v15 offset:55296
    v_mfma_f32_16x16x32_bf16 v[88:91], a[164:167], v[200:203], v[88:91]
    v_mfma_f32_16x16x32_bf16 v[92:95], a[156:159], v[204:207], v[92:95]
    buffer_load_dwordx4 a[28:31], v14, s[48:51], s84 offen offset:1024 sc1
    v_mfma_f32_16x16x32_bf16 v[96:99], a[160:163], v[204:207], v[96:99]
    v_mfma_f32_16x16x32_bf16 v[100:103], a[164:167], v[204:207], v[100:103]
    s_waitcnt lgkmcnt(3)
    ds_read_b128 v[200:203], v15 offset:57344
    v_mfma_f32_16x16x32_bf16 v[104:107], a[156:159], v[208:211], v[104:107]
    v_mfma_f32_16x16x32_bf16 v[108:111], a[160:163], v[208:211], v[108:111]
    ds_read_b128 v[204:207], v15 offset:59392
    v_mfma_f32_16x16x32_bf16 v[112:115], a[164:167], v[208:211], v[112:115]
    s_lshl_b32 s84, s66, 3
    v_mfma_f32_16x16x32_bf16 v[116:119], a[156:159], v[212:215], v[116:119]
    buffer_load_dwordx4 a[32:35], v13, s[48:51], s84 offen offset:0 sc1
    v_mfma_f32_16x16x32_bf16 v[120:123], a[160:163], v[212:215], v[120:123]
    ds_read_b128 v[208:211], v15 offset:61440
    v_mfma_f32_16x16x32_bf16 v[124:127], a[164:167], v[212:215], v[124:127]
    v_mfma_f32_16x16x32_bf16 v[32:35], a[168:171], a[240:243], v[32:35]
    buffer_load_dwordx4 a[36:39], v13, s[48:51], s84 offen offset:1024 sc1
    v_mfma_f32_16x16x32_bf16 v[36:39], a[172:175], a[240:243], v[36:39]
    v_mfma_f32_16x16x32_bf16 v[40:43], a[176:179], a[240:243], v[40:43]
    s_waitcnt lgkmcnt(3)
    ds_read_b128 v[212:215], v15 offset:63488
    v_mfma_f32_16x16x32_bf16 v[44:47], a[168:171], a[244:247], v[44:47]
    v_mfma_f32_16x16x32_bf16 v[48:51], a[172:175], a[244:247], v[48:51]
    ds_read_b128 a[240:243], v15 offset:50176
    v_mfma_f32_16x16x32_bf16 v[52:55], a[176:179], a[244:247], v[52:55]
    buffer_load_dwordx4 a[40:43], v14, s[48:51], s84 offen offset:0 sc1
    v_mfma_f32_16x16x32_bf16 v[56:59], a[168:171], a[248:251], v[56:59]
    v_mfma_f32_16x16x32_bf16 v[60:63], a[172:175], a[248:251], v[60:63]
    ds_read_b128 a[244:247], v15 offset:52224
    v_mfma_f32_16x16x32_bf16 v[64:67], a[176:179], a[248:251], v[64:67]
    buffer_load_dwordx4 a[44:47], v14, s[48:51], s84 offen offset:1024 sc1
    v_mfma_f32_16x16x32_bf16 v[68:71], a[168:171], a[252:255], v[68:71]
    v_mfma_f32_16x16x32_bf16 v[72:75], a[172:175], a[252:255], v[72:75]
    v_mfma_f32_16x16x32_bf16 v[76:79], a[176:179], a[252:255], v[76:79]
    s_waitcnt lgkmcnt(3)
    ds_read_b128 a[248:251], v15 offset:54272
    v_mfma_f32_16x16x32_bf16 v[80:83], a[168:171], v[200:203], v[80:83]
    v_mfma_f32_16x16x32_bf16 v[84:87], a[172:175], v[200:203], v[84:87]
    ds_read_b128 a[252:255], v15 offset:56320
    s_lshl_b32 s84, s67, 3
    v_mfma_f32_16x16x32_bf16 v[88:91], a[176:179], v[200:203], v[88:91]
    buffer_load_dwordx4 a[48:51], v13, s[48:51], s84 offen offset:0 sc1
    v_mfma_f32_16x16x32_bf16 v[92:95], a[168:171], v[204:207], v[92:95]
    v_mfma_f32_16x16x32_bf16 v[96:99], a[172:175], v[204:207], v[96:99]
    ds_read_b128 v[200:203], v15 offset:58368
    v_mfma_f32_16x16x32_bf16 v[100:103], a[176:179], v[204:207], v[100:103]
    buffer_load_dwordx4 a[52:55], v13, s[48:51], s84 offen offset:1024 sc1
    v_mfma_f32_16x16x32_bf16 v[104:107], a[168:171], v[208:211], v[104:107]
    v_mfma_f32_16x16x32_bf16 v[108:111], a[172:175], v[208:211], v[108:111]
    v_mfma_f32_16x16x32_bf16 v[112:115], a[176:179], v[208:211], v[112:115]
    s_waitcnt lgkmcnt(3)
    ds_read_b128 v[204:207], v15 offset:60416
    v_mfma_f32_16x16x32_bf16 v[116:119], a[168:171], v[212:215], v[116:119]
    buffer_load_dwordx4 a[56:59], v14, s[48:51], s84 offen offset:0 sc1
    v_mfma_f32_16x16x32_bf16 v[120:123], a[172:175], v[212:215], v[120:123]
    ds_read_b128 v[208:211], v15 offset:62464
    v_mfma_f32_16x16x32_bf16 v[124:127], a[176:179], v[212:215], v[124:127]
    v_mfma_f32_16x16x32_bf16 v[32:35], a[180:183], a[240:243], v[32:35]
    v_mfma_f32_16x16x32_bf16 v[36:39], a[184:187], a[240:243], v[36:39]
    ds_read_b128 v[212:215], v15 offset:64512
    v_mfma_f32_16x16x32_bf16 v[40:43], a[188:191], a[240:243], v[40:43]
    buffer_load_dwordx4 a[60:63], v14, s[48:51], s84 offen offset:1024 sc1
    v_mfma_f32_16x16x32_bf16 v[44:47], a[180:183], a[244:247], v[44:47]
    v_mfma_f32_16x16x32_bf16 v[48:51], a[184:187], a[244:247], v[48:51]
    v_mfma_f32_16x16x32_bf16 v[52:55], a[188:191], a[244:247], v[52:55]
    s_waitcnt lgkmcnt(3)
    v_mfma_f32_16x16x32_bf16 v[56:59], a[180:183], a[248:251], v[56:59]
    s_waitcnt vmcnt(14)
    s_barrier
    v_mfma_f32_16x16x32_bf16 v[60:63], a[184:187], a[248:251], v[60:63]
    ds_read_b128 a[240:243], v16 offset:0
    s_lshl_b32 s84, s68, 3
    v_mfma_f32_16x16x32_bf16 v[64:67], a[188:191], a[248:251], v[64:67]
    buffer_load_dwordx4 a[64:67], v13, s[48:51], s84 offen offset:0 sc1
    v_mfma_f32_16x16x32_bf16 v[68:71], a[180:183], a[252:255], v[68:71]
    ds_read_b128 a[244:247], v16 offset:2048
    v_mfma_f32_16x16x32_bf16 v[72:75], a[184:187], a[252:255], v[72:75]
    ds_read_b128 a[248:251], v16 offset:4096
    v_mfma_f32_16x16x32_bf16 v[76:79], a[188:191], a[252:255], v[76:79]
    buffer_load_dwordx4 a[68:71], v13, s[48:51], s84 offen offset:1024 sc1
    v_mfma_f32_16x16x32_bf16 v[80:83], a[180:183], v[200:203], v[80:83]
    v_mfma_f32_16x16x32_bf16 v[84:87], a[184:187], v[200:203], v[84:87]
    v_mfma_f32_16x16x32_bf16 v[88:91], a[188:191], v[200:203], v[88:91]
    s_waitcnt lgkmcnt(3)
    ds_read_b128 a[252:255], v16 offset:6144
    v_mfma_f32_16x16x32_bf16 v[92:95], a[180:183], v[204:207], v[92:95]
    buffer_load_dwordx4 a[72:75], v14, s[48:51], s84 offen offset:0 sc1
    v_mfma_f32_16x16x32_bf16 v[96:99], a[184:187], v[204:207], v[96:99]
    ds_read_b128 v[200:203], v16 offset:1024
    v_mfma_f32_16x16x32_bf16 v[100:103], a[188:191], v[204:207], v[100:103]
    v_mfma_f32_16x16x32_bf16 v[104:107], a[180:183], v[208:211], v[104:107]
    buffer_load_dwordx4 a[76:79], v14, s[48:51], s84 offen offset:1024 sc1
    v_mfma_f32_16x16x32_bf16 v[108:111], a[184:187], v[208:211], v[108:111]
    ds_read_b128 v[204:207], v16 offset:3072
    v_mfma_f32_16x16x32_bf16 v[112:115], a[188:191], v[208:211], v[112:115]
    v_mfma_f32_16x16x32_bf16 v[116:119], a[180:183], v[212:215], v[116:119]
    v_mfma_f32_16x16x32_bf16 v[120:123], a[184:187], v[212:215], v[120:123]
    v_mfma_f32_16x16x32_bf16 v[124:127], a[188:191], v[212:215], v[124:127]
    s_waitcnt lgkmcnt(3)
    ds_read_b128 v[208:211], v16 offset:5120
    v_mfma_f32_16x16x32_bf16 v[32:35], a[192:195], a[240:243], v[32:35]
    s_lshl_b32 s84, s69, 3
    v_mfma_f32_16x16x32_bf16 v[36:39], a[196:199], a[240:243], v[36:39]
    buffer_load_dwordx4 a[80:83], v13, s[48:51], s84 offen offset:0 sc1
    v_mfma_f32_16x16x32_bf16 v[40:43], a[200:203], a[240:243], v[40:43]
    ds_read_b128 v[212:215], v16 offset:7168
    v_mfma_f32_16x16x32_bf16 v[44:47], a[192:195], a[244:247], v[44:47]
    buffer_load_dwordx4 a[84:87], v13, s[48:51], s84 offen offset:1024 sc1
    v_mfma_f32_16x16x32_bf16 v[48:51], a[196:199], a[244:247], v[48:51]
    ds_read_b128 a[240:243], v16 offset:16384
    v_mfma_f32_16x16x32_bf16 v[52:55], a[200:203], a[244:247], v[52:55]
    v_mfma_f32_16x16x32_bf16 v[56:59], a[192:195], a[248:251], v[56:59]
    v_mfma_f32_16x16x32_bf16 v[60:63], a[196:199], a[248:251], v[60:63]
    v_mfma_f32_16x16x32_bf16 v[64:67], a[200:203], a[248:251], v[64:67]
    s_waitcnt lgkmcnt(3)
    ds_read_b128 a[244:247], v16 offset:18432
    v_mfma_f32_16x16x32_bf16 v[68:71], a[192:195], a[252:255], v[68:71]
    buffer_load_dwordx4 a[88:91], v14, s[48:51], s84 offen offset:0 sc1
    v_mfma_f32_16x16x32_bf16 v[72:75], a[196:199], a[252:255], v[72:75]
    ds_read_b128 a[248:251], v16 offset:20480
    v_mfma_f32_16x16x32_bf16 v[76:79], a[200:203], a[252:255], v[76:79]
    buffer_load_dwordx4 a[92:95], v14, s[48:51], s84 offen offset:1024 sc1
    v_mfma_f32_16x16x32_bf16 v[32:35], a[204:207], v[200:203], v[32:35]
    v_mfma_f32_16x16x32_bf16 v[36:39], a[208:211], v[200:203], v[36:39]
    ds_read_b128 a[252:255], v16 offset:22528
    v_mfma_f32_16x16x32_bf16 v[40:43], a[212:215], v[200:203], v[40:43]
    v_mfma_f32_16x16x32_bf16 v[44:47], a[204:207], v[204:207], v[44:47]
    v_mfma_f32_16x16x32_bf16 v[48:51], a[208:211], v[204:207], v[48:51]
    v_mfma_f32_16x16x32_bf16 v[52:55], a[212:215], v[204:207], v[52:55]
    s_waitcnt lgkmcnt(3)
    ds_read_b128 v[200:203], v16 offset:17408
    v_mfma_f32_16x16x32_bf16 v[56:59], a[204:207], v[208:211], v[56:59]
    s_lshl_b32 s84, s70, 3
    v_mfma_f32_16x16x32_bf16 v[60:63], a[208:211], v[208:211], v[60:63]
    buffer_load_dwordx4 a[96:99], v13, s[48:51], s84 offen offset:0 sc1
    v_mfma_f32_16x16x32_bf16 v[64:67], a[212:215], v[208:211], v[64:67]
    ds_read_b128 v[204:207], v16 offset:19456
    v_mfma_f32_16x16x32_bf16 v[68:71], a[204:207], v[212:215], v[68:71]
    buffer_load_dwordx4 a[100:103], v13, s[48:51], s84 offen offset:1024 sc1
    v_mfma_f32_16x16x32_bf16 v[72:75], a[208:211], v[212:215], v[72:75]
    ds_read_b128 v[208:211], v16 offset:21504
    v_mfma_f32_16x16x32_bf16 v[76:79], a[212:215], v[212:215], v[76:79]
    v_mfma_f32_16x16x32_bf16 v[32:35], a[216:219], a[240:243], v[32:35]
    buffer_load_dwordx4 a[104:107], v14, s[48:51], s84 offen offset:0 sc1
    v_mfma_f32_16x16x32_bf16 v[36:39], a[220:223], a[240:243], v[36:39]
    v_mfma_f32_16x16x32_bf16 v[40:43], a[224:227], a[240:243], v[40:43]
    s_waitcnt lgkmcnt(3)
    ds_read_b128 v[212:215], v16 offset:23552
    v_mfma_f32_16x16x32_bf16 v[44:47], a[216:219], a[244:247], v[44:47]
    v_mfma_f32_16x16x32_bf16 v[48:51], a[220:223], a[244:247], v[48:51]
    ds_read_b128 a[240:243], v16 offset:8192
    v_mfma_f32_16x16x32_bf16 v[52:55], a[224:227], a[244:247], v[52:55]
    buffer_load_dwordx4 a[108:111], v14, s[48:51], s84 offen offset:1024 sc1
    v_mfma_f32_16x16x32_bf16 v[56:59], a[216:219], a[248:251], v[56:59]
    v_mfma_f32_16x16x32_bf16 v[60:63], a[220:223], a[248:251], v[60:63]
    ds_read_b128 a[244:247], v16 offset:10240
    v_mfma_f32_16x16x32_bf16 v[64:67], a[224:227], a[248:251], v[64:67]
    v_mfma_f32_16x16x32_bf16 v[68:71], a[216:219], a[252:255], v[68:71]
    s_lshl_b32 s84, s71, 3
    v_mfma_f32_16x16x32_bf16 v[72:75], a[220:223], a[252:255], v[72:75]
    buffer_load_dwordx4 a[112:115], v13, s[48:51], s84 offen offset:0 sc1
    v_mfma_f32_16x16x32_bf16 v[76:79], a[224:227], a[252:255], v[76:79]
    s_waitcnt lgkmcnt(3)
    ds_read_b128 a[248:251], v16 offset:12288
    v_mfma_f32_16x16x32_bf16 v[32:35], a[228:231], v[200:203], v[32:35]
    v_mfma_f32_16x16x32_bf16 v[36:39], a[232:235], v[200:203], v[36:39]
    ds_read_b128 a[252:255], v16 offset:14336
    v_mfma_f32_16x16x32_bf16 v[40:43], a[236:239], v[200:203], v[40:43]
    buffer_load_dwordx4 a[116:119], v13, s[48:51], s84 offen offset:1024 sc1
    v_mfma_f32_16x16x32_bf16 v[44:47], a[228:231], v[204:207], v[44:47]
    buffer_load_dword v18, v218, s[48:51], 0 offen sc0 sc1
    v_mfma_f32_16x16x32_bf16 v[48:51], a[232:235], v[204:207], v[48:51]
    ds_read_b128 v[200:203], v16 offset:9216
    v_mfma_f32_16x16x32_bf16 v[52:55], a[236:239], v[204:207], v[52:55]
    buffer_load_dwordx4 a[120:123], v14, s[48:51], s84 offen offset:0 sc1
    v_mfma_f32_16x16x32_bf16 v[56:59], a[228:231], v[208:211], v[56:59]
    v_mfma_f32_16x16x32_bf16 v[60:63], a[232:235], v[208:211], v[60:63]
    v_mfma_f32_16x16x32_bf16 v[64:67], a[236:239], v[208:211], v[64:67]
    s_waitcnt lgkmcnt(3)
    ds_read_b128 v[204:207], v16 offset:11264
    v_mfma_f32_16x16x32_bf16 v[68:71], a[228:231], v[212:215], v[68:71]
    buffer_load_dwordx4 a[124:127], v14, s[48:51], s84 offen offset:1024 sc1
    v_mfma_f32_16x16x32_bf16 v[72:75], a[232:235], v[212:215], v[72:75]
    ds_read_b128 v[208:211], v16 offset:13312
    v_mfma_f32_16x16x32_bf16 v[76:79], a[236:239], v[212:215], v[76:79]
    v_mfma_f32_16x16x32_bf16 v[80:83], a[192:195], a[240:243], v[80:83]
    v_mfma_f32_16x16x32_bf16 v[84:87], a[196:199], a[240:243], v[84:87]
    ds_read_b128 v[212:215], v16 offset:15360
    v_mfma_f32_16x16x32_bf16 v[88:91], a[200:203], a[240:243], v[88:91]
    s_lshl_b32 s84, s72, 3
    v_mfma_f32_16x16x32_bf16 v[92:95], a[192:195], a[244:247], v[92:95]
    buffer_load_dwordx4 a[128:131], v13, s[48:51], s84 offen offset:0 sc1
    v_mfma_f32_16x16x32_bf16 v[96:99], a[196:199], a[244:247], v[96:99]
    v_permlane32_swap_b32 v40, v52
    v_permlane32_swap_b32 v41, v53
    v_mfma_f32_16x16x32_bf16 v[100:103], a[200:203], a[244:247], v[100:103]
    v_permlane32_swap_b32 v42, v54
    v_permlane32_swap_b32 v43, v55
    s_waitcnt lgkmcnt(3)
    v_mfma_f32_16x16x32_bf16 v[104:107], a[192:195], a[248:251], v[104:107]
    ds_read_b128 a[240:243], v16 offset:24576
    v_permlane32_swap_b32 v64, v76
    v_mfma_f32_16x16x32_bf16 v[108:111], a[196:199], a[248:251], v[108:111]
    v_permlane32_swap_b32 v65, v77
    v_permlane32_swap_b32 v66, v78
    v_mfma_f32_16x16x32_bf16 v[112:115], a[200:203], a[248:251], v[112:115]
    buffer_load_dwordx4 a[132:135], v13, s[48:51], s84 offen offset:1024 sc1
    v_mfma_f32_16x16x32_bf16 v[116:119], a[192:195], a[252:255], v[116:119]
    v_permlane32_swap_b32 v67, v79
    ds_read_b128 a[244:247], v16 offset:26624
    v_mfma_f32_16x16x32_bf16 v[120:123], a[196:199], a[252:255], v[120:123]
    v_max_f32 v32, 0, v32
    v_max_f32 v33, 0, v33
    v_mfma_f32_16x16x32_bf16 v[124:127], a[200:203], a[252:255], v[124:127]
    v_max_f32 v34, 0, v34
    v_max_f32 v35, 0, v35
    v_mfma_f32_16x16x32_bf16 v[80:83], a[204:207], v[200:203], v[80:83]
    v_mul_f32 v32, v32, v36
    v_mul_f32 v33, v33, v37
    v_mfma_f32_16x16x32_bf16 v[84:87], a[208:211], v[200:203], v[84:87]
    ds_read_b128 a[248:251], v16 offset:28672
    v_mfma_f32_16x16x32_bf16 v[88:91], a[212:215], v[200:203], v[88:91]
    buffer_load_dwordx4 a[136:139], v14, s[48:51], s84 offen offset:0 sc1
    v_mul_f32 v34, v34, v38
    v_mul_f32 v35, v35, v39
    v_cvt_pk_bf16_f32 v128, v32, v33
    v_cvt_pk_bf16_f32 v129, v34, v35
    s_waitcnt lgkmcnt(3)
    v_mfma_f32_16x16x32_bf16 v[92:95], a[204:207], v[204:207], v[92:95]
    ds_read_b128 a[252:255], v16 offset:30720
    v_max_f32 v44, 0, v44
    v_mfma_f32_16x16x32_bf16 v[96:99], a[208:211], v[204:207], v[96:99]
    v_max_f32 v45, 0, v45
    v_mfma_f32_16x16x32_bf16 v[100:103], a[212:215], v[204:207], v[100:103]
    buffer_load_dwordx4 a[140:143], v14, s[48:51], s84 offen offset:1024 sc1
    v_mfma_f32_16x16x32_bf16 v[104:107], a[204:207], v[208:211], v[104:107]
    v_max_f32 v46, 0, v46
    v_max_f32 v47, 0, v47
    v_mfma_f32_16x16x32_bf16 v[108:111], a[208:211], v[208:211], v[108:111]
    v_mul_f32 v44, v44, v48
    ds_read_b128 v[200:203], v16 offset:25600
    v_mfma_f32_16x16x32_bf16 v[112:115], a[212:215], v[208:211], v[112:115]
    v_mul_f32 v45, v45, v49
    v_mul_f32 v46, v46, v50
    v_mfma_f32_16x16x32_bf16 v[116:119], a[204:207], v[212:215], v[116:119]
    v_mul_f32 v47, v47, v51
    v_cvt_pk_bf16_f32 v130, v44, v45
    v_mfma_f32_16x16x32_bf16 v[120:123], a[208:211], v[212:215], v[120:123]
    v_cvt_pk_bf16_f32 v131, v46, v47
    ds_read_b128 v[204:207], v16 offset:27648
    v_mfma_f32_16x16x32_bf16 v[124:127], a[212:215], v[212:215], v[124:127]
    s_lshl_b32 s84, s73, 3
    buffer_load_dwordx4 a[144:147], v13, s[48:51], s84 offen offset:0 sc1
    v_max_f32 v40, 0, v40
    v_max_f32 v41, 0, v41
    v_max_f32 v42, 0, v42
    v_max_f32 v43, 0, v43
    v_mul_f32 v40, v40, v52
    s_waitcnt lgkmcnt(3)
    v_mfma_f32_16x16x32_bf16 v[80:83], a[216:219], a[240:243], v[80:83]
    ds_read_b128 v[208:211], v16 offset:29696
    v_mul_f32 v41, v41, v53
    v_mfma_f32_16x16x32_bf16 v[84:87], a[220:223], a[240:243], v[84:87]
    buffer_load_dwordx4 a[148:151], v13, s[48:51], s84 offen offset:1024 sc1
    v_mfma_f32_16x16x32_bf16 v[88:91], a[224:227], a[240:243], v[88:91]
    v_mul_f32 v42, v42, v54
    v_mul_f32 v43, v43, v55
    v_mfma_f32_16x16x32_bf16 v[92:95], a[216:219], a[244:247], v[92:95]
    v_cvt_pk_bf16_f32 v136, v40, v41
    ds_read_b128 v[212:215], v16 offset:31744
    v_mfma_f32_16x16x32_bf16 v[96:99], a[220:223], a[244:247], v[96:99]
    v_cvt_pk_bf16_f32 v137, v42, v43
    v_permlane32_swap_b32 v128, v130
    v_mfma_f32_16x16x32_bf16 v[100:103], a[224:227], a[244:247], v[100:103]
    v_permlane32_swap_b32 v129, v131
    v_max_f32 v56, 0, v56
    v_mfma_f32_16x16x32_bf16 v[104:107], a[216:219], a[248:251], v[104:107]
    buffer_load_dwordx4 a[152:155], v14, s[48:51], s84 offen offset:0 sc1
    v_mfma_f32_16x16x32_bf16 v[108:111], a[220:223], a[248:251], v[108:111]
    v_max_f32 v57, 0, v57
    ds_read_b128 a[240:243], v1 offset:0
    v_mfma_f32_16x16x32_bf16 v[112:115], a[224:227], a[248:251], v[112:115]
    v_max_f32 v58, 0, v58
    v_max_f32 v59, 0, v59
    v_mul_f32 v56, v56, v60
    v_mul_f32 v57, v57, v61
    v_mul_f32 v58, v58, v62
    s_waitcnt lgkmcnt(3)
    v_mfma_f32_16x16x32_bf16 v[116:119], a[216:219], a[252:255], v[116:119]
    ds_read_b128 a[244:247], v1 offset:2048
    v_mfma_f32_16x16x32_bf16 v[120:123], a[220:223], a[252:255], v[120:123]
    buffer_load_dwordx4 a[156:159], v14, s[48:51], s84 offen offset:1024 sc1
    v_mfma_f32_16x16x32_bf16 v[124:127], a[224:227], a[252:255], v[124:127]
    v_mul_f32 v59, v59, v63
    v_cvt_pk_bf16_f32 v132, v56, v57
    v_mfma_f32_16x16x32_bf16 v[80:83], a[228:231], v[200:203], v[80:83]
    v_cvt_pk_bf16_f32 v133, v58, v59
    v_max_f32 v68, 0, v68
    v_mfma_f32_16x16x32_bf16 v[84:87], a[232:235], v[200:203], v[84:87]
    v_max_f32 v69, 0, v69
    ds_read_b128 a[248:251], v1 offset:1024
    v_mfma_f32_16x16x32_bf16 v[88:91], a[236:239], v[200:203], v[88:91]
    v_max_f32 v70, 0, v70
    v_max_f32 v71, 0, v71
    v_mfma_f32_16x16x32_bf16 v[92:95], a[228:231], v[204:207], v[92:95]
    v_mul_f32 v68, v68, v72
    v_mul_f32 v69, v69, v73
    v_mfma_f32_16x16x32_bf16 v[96:99], a[232:235], v[204:207], v[96:99]
    v_mul_f32 v70, v70, v74
    ds_read_b128 a[252:255], v1 offset:3072
    v_mfma_f32_16x16x32_bf16 v[100:103], a[236:239], v[204:207], v[100:103]
    v_mul_f32 v71, v71, v75
    v_cvt_pk_bf16_f32 v134, v68, v69
    v_cvt_pk_bf16_f32 v135, v70, v71
    v_max_f32 v64, 0, v64
    v_max_f32 v65, 0, v65
    v_max_f32 v66, 0, v66
    s_waitcnt lgkmcnt(3)
    v_mfma_f32_16x16x32_bf16 v[104:107], a[228:231], v[208:211], v[104:107]
    ds_read_b128 v[200:203], v1 offset:16384
    s_waitcnt vmcnt(10)
    v_mfma_f32_16x16x32_bf16 v[108:111], a[232:235], v[208:211], v[108:111]
    v_cmp_ne_u32 vcc, s9, v18
    v_mfma_f32_16x16x32_bf16 v[112:115], a[236:239], v[208:211], v[112:115]
    v_mfma_f32_16x16x32_bf16 v[116:119], a[228:231], v[212:215], v[116:119]
    s_cbranch_vccnz L_plp6
L_pok5:
    s_add_u32 s30, s80, 0
    v_mfma_f32_16x16x32_bf16 v[120:123], a[232:235], v[212:215], v[120:123]
    buffer_load_dwordx4 v[176:179], v1, s[48:51], s30 offen offset:0 sc1
    v_mfma_f32_16x16x32_bf16 v[124:127], a[236:239], v[212:215], v[124:127]
    v_max_f32 v67, 0, v67
    v_mul_f32 v64, v64, v76
    v_mfma_f32_16x16x32_bf16 v[144:147], a[0:3], a[240:243], 0
    v_mul_f32 v65, v65, v77
    ds_read_b128 v[204:207], v1 offset:18432
    v_mfma_f32_16x16x32_bf16 v[148:151], a[240:243], a[4:7], 0
    v_mul_f32 v66, v66, v78
    v_mul_f32 v67, v67, v79
    v_cvt_pk_bf16_f32 v138, v64, v65
    v_cvt_pk_bf16_f32 v139, v66, v67
    v_permlane32_swap_b32 v132, v134
    v_permlane32_swap_b32 v133, v135
    ds_read_b128 v[208:211], v1 offset:17408
    v_permlane16_swap_b32 v136, v138
    v_permlane16_swap_b32 v137, v139
    s_add_u32 s25, s76, 0
    s_waitcnt lgkmcnt(3)
    v_mfma_f32_16x16x32_bf16 v[152:155], a[0:3], a[244:247], 0
    ds_read_b128 v[212:215], v1 offset:19456
    s_add_u32 s26, s76, 139264
    v_mfma_f32_16x16x32_bf16 v[156:159], a[244:247], a[4:7], 0
    buffer_store_dwordx4 v[128:131], v222, s[48:51], s25 offen sc0 sc1
    v_mfma_f32_16x16x32_bf16 v[144:147], a[8:11], a[248:251], v[144:147]
    buffer_load_dwordx4 v[180:183], v1, s[48:51], s30 offen offset:1024 sc1
    v_mfma_f32_16x16x32_bf16 v[148:151], a[248:251], a[12:15], v[148:151]
    buffer_store_dwordx4 v[132:135], v222, s[48:51], s26 offen sc0 sc1
    v_mfma_f32_16x16x32_bf16 v[152:155], a[8:11], a[252:255], v[152:155]
    ds_read_b128 a[240:243], v1 offset:32768
    v_mfma_f32_16x16x32_bf16 v[156:159], a[252:255], a[12:15], v[156:159]
    buffer_store_dwordx4 v[136:139], v223, s[48:51], s25 offen offset:2048 sc0 sc1
    ds_read_b128 a[244:247], v1 offset:34816
    v_permlane32_swap_b32 v88, v100
    v_permlane32_swap_b32 v89, v101
    v_permlane32_swap_b32 v90, v102
    s_waitcnt lgkmcnt(3)
    v_mfma_f32_16x16x32_bf16 v[144:147], a[16:19], v[200:203], v[144:147]
    ds_read_b128 a[248:251], v1 offset:33792
    v_permlane32_swap_b32 v91, v103
    v_mfma_f32_16x16x32_bf16 v[148:151], v[200:203], a[20:23], v[148:151]
    v_permlane32_swap_b32 v112, v124
    v_permlane32_swap_b32 v113, v125
    v_mfma_f32_16x16x32_bf16 v[152:155], a[16:19], v[204:207], v[152:155]
    ds_read_b128 a[252:255], v1 offset:35840
    v_permlane32_swap_b32 v114, v126
    v_mfma_f32_16x16x32_bf16 v[156:159], v[204:207], a[20:23], v[156:159]
    v_permlane32_swap_b32 v115, v127
    v_mfma_f32_16x16x32_bf16 v[144:147], a[24:27], v[208:211], v[144:147]
    buffer_load_dwordx4 v[184:187], v1, s[48:51], s30 offen offset:2048 sc1
    v_mfma_f32_16x16x32_bf16 v[148:151], v[208:211], a[28:31], v[148:151]
    v_max_f32 v80, 0, v80
    ds_read_b128 v[200:203], v1 offset:49152
    v_max_f32 v81, 0, v81
    v_max_f32 v82, 0, v82
    v_max_f32 v83, 0, v83
    s_waitcnt lgkmcnt(3)
    v_mfma_f32_16x16x32_bf16 v[152:155], a[24:27], v[212:215], v[152:155]
    ds_read_b128 v[204:207], v1 offset:51200
    v_mul_f32 v80, v80, v84
    v_mfma_f32_16x16x32_bf16 v[156:159], v[212:215], a[28:31], v[156:159]
    v_mul_f32 v81, v81, v85
    v_mfma_f32_16x16x32_bf16 v[144:147], a[32:35], a[240:243], v[144:147]
    buffer_load_dword v18, v219, s[48:51], 0 offen sc0 sc1
    v_mfma_f32_16x16x32_bf16 v[148:151], a[240:243], a[36:39], v[148:151]
    v_mul_f32 v82, v82, v86
    ds_read_b128 v[208:211], v1 offset:50176
    v_mfma_f32_16x16x32_bf16 v[152:155], a[32:35], a[244:247], v[152:155]
    v_mul_f32 v83, v83, v87
    v_cvt_pk_bf16_f32 v128, v80, v81
    v_mfma_f32_16x16x32_bf16 v[156:159], a[244:247], a[36:39], v[156:159]
    v_cvt_pk_bf16_f32 v129, v82, v83
    ds_read_b128 v[212:215], v1 offset:52224
    v_max_f32 v92, 0, v92
    v_max_f32 v93, 0, v93
    buffer_load_dwordx4 v[188:191], v1, s[48:51], s30 offen offset:3072 sc1
    v_max_f32 v94, 0, v94
    s_waitcnt lgkmcnt(3)
    v_mfma_f32_16x16x32_bf16 v[144:147], a[40:43], a[248:251], v[144:147]
    ds_read_b128 a[240:243], v15 offset:0
    v_max_f32 v95, 0, v95
    v_mfma_f32_16x16x32_bf16 v[148:151], a[248:251], a[44:47], v[148:151]
    v_mul_f32 v92, v92, v96
    v_mul_f32 v93, v93, v97
    v_mfma_f32_16x16x32_bf16 v[152:155], a[40:43], a[252:255], v[152:155]
    ds_read_b128 a[244:247], v15 offset:2048
    v_mul_f32 v94, v94, v98
    v_mfma_f32_16x16x32_bf16 v[156:159], a[252:255], a[44:47], v[156:159]
    v_mul_f32 v95, v95, v99
    v_cvt_pk_bf16_f32 v130, v92, v93
    v_mfma_f32_16x16x32_bf16 v[144:147], a[48:51], v[200:203], v[144:147]
    v_cvt_pk_bf16_f32 v131, v94, v95
    ds_read_b128 a[248:251], v15 offset:1024
    v_mfma_f32_16x16x32_bf16 v[148:151], v[200:203], a[52:55], v[148:151]
    v_max_f32 v88, 0, v88
    v_max_f32 v89, 0, v89
    v_max_f32 v90, 0, v90
    s_waitcnt lgkmcnt(3)
    v_mfma_f32_16x16x32_bf16 v[152:155], a[48:51], v[204:207], v[152:155]
    ds_read_b128 a[252:255], v15 offset:3072
    v_max_f32 v91, 0, v91
    v_mfma_f32_16x16x32_bf16 v[156:159], v[204:207], a[52:55], v[156:159]
    v_mul_f32 v88, v88, v100
    v_mfma_f32_16x16x32_bf16 v[144:147], a[56:59], v[208:211], v[144:147]
    buffer_load_dwordx4 v[192:195], v224, s[48:51], s30 offen offset:0 sc1
    v_mfma_f32_16x16x32_bf16 v[148:151], v[208:211], a[60:63], v[148:151]
    v_mul_f32 v89, v89, v101
    ds_read_b128 v[200:203], v15 offset:16384
    v_mfma_f32_16x16x32_bf16 v[152:155], a[56:59], v[212:215], v[152:155]
    v_mul_f32 v90, v90, v102
    v_mul_f32 v91, v91, v103
    v_mfma_f32_16x16x32_bf16 v[156:159], v[212:215], a[60:63], v[156:159]
    v_cvt_pk_bf16_f32 v136, v88, v89
    ds_read_b128 v[204:207], v15 offset:18432
    v_cvt_pk_bf16_f32 v137, v90, v91
    v_permlane32_swap_b32 v128, v130
    v_permlane32_swap_b32 v129, v131
    v_max_f32 v104, 0, v104
    s_waitcnt lgkmcnt(3)
    v_mfma_f32_16x16x32_bf16 v[144:147], a[64:67], a[240:243], v[144:147]
    ds_read_b128 v[208:211], v15 offset:17408
    v_max_f32 v105, 0, v105
    v_mfma_f32_16x16x32_bf16 v[148:151], a[240:243], a[68:71], v[148:151]
    v_max_f32 v106, 0, v106
    v_max_f32 v107, 0, v107
    v_mfma_f32_16x16x32_bf16 v[152:155], a[64:67], a[244:247], v[152:155]
    ds_read_b128 v[212:215], v15 offset:19456
    v_mul_f32 v104, v104, v108
    v_mfma_f32_16x16x32_bf16 v[156:159], a[244:247], a[68:71], v[156:159]
    v_mul_f32 v105, v105, v109
    v_mul_f32 v106, v106, v110
    v_mfma_f32_16x16x32_bf16 v[144:147], a[72:75], a[248:251], v[144:147]
    v_mul_f32 v107, v107, v111
    ds_read_b128 a[240:243], v15 offset:32768
    v_mfma_f32_16x16x32_bf16 v[148:151], a[248:251], a[76:79], v[148:151]
    s_add_u32 s30, s80, 5120
    buffer_load_dwordx4 v[196:199], v1, s[48:51], s30 offen offset:0 sc1
    v_cvt_pk_bf16_f32 v132, v104, v105
    v_cvt_pk_bf16_f32 v133, v106, v107
    s_waitcnt lgkmcnt(3)
    v_mfma_f32_16x16x32_bf16 v[152:155], a[72:75], a[252:255], v[152:155]
    ds_read_b128 a[244:247], v15 offset:34816
    v_max_f32 v116, 0, v116
    v_mfma_f32_16x16x32_bf16 v[156:159], a[252:255], a[76:79], v[156:159]
    v_max_f32 v117, 0, v117
    v_max_f32 v118, 0, v118
    v_mfma_f32_16x16x32_bf16 v[144:147], a[80:83], v[200:203], v[144:147]
    v_max_f32 v119, 0, v119
    ds_read_b128 a[248:251], v15 offset:33792
    v_mfma_f32_16x16x32_bf16 v[148:151], v[200:203], a[84:87], v[148:151]
    v_mul_f32 v116, v116, v120
    v_mul_f32 v117, v117, v121
    v_mfma_f32_16x16x32_bf16 v[152:155], a[80:83], v[204:207], v[152:155]
    v_mul_f32 v118, v118, v122
    ds_read_b128 a[252:255], v15 offset:35840
    v_mfma_f32_16x16x32_bf16 v[156:159], v[204:207], a[84:87], v[156:159]
    v_mul_f32 v119, v119, v123
    v_cvt_pk_bf16_f32 v134, v116, v117
    v_cvt_pk_bf16_f32 v135, v118, v119
    v_max_f32 v112, 0, v112
    s_waitcnt lgkmcnt(3)
    v_mfma_f32_16x16x32_bf16 v[144:147], a[88:91], v[208:211], v[144:147]
    ds_read_b128 v[200:203], v15 offset:49152
    v_mfma_f32_16x16x32_bf16 v[148:151], v[208:211], a[92:95], v[148:151]
    buffer_load_dwordx4 v[32:35], v1, s[48:51], s30 offen offset:1024 sc1
    v_mfma_f32_16x16x32_bf16 v[152:155], a[88:91], v[212:215], v[152:155]
    v_max_f32 v113, 0, v113
    v_max_f32 v114, 0, v114
    v_mfma_f32_16x16x32_bf16 v[156:159], v[212:215], a[92:95], v[156:159]
    ds_read_b128 v[204:207], v15 offset:51200
    v_max_f32 v115, 0, v115
    v_mfma_f32_16x16x32_bf16 v[144:147], a[96:99], a[240:243], v[144:147]
    v_mul_f32 v112, v112, v124
    v_mul_f32 v113, v113, v125
    v_mfma_f32_16x16x32_bf16 v[148:151], a[240:243], a[100:103], v[148:151]
    v_mul_f32 v114, v114, v126
    ds_read_b128 v[208:211], v15 offset:50176
    v_mul_f32 v115, v115, v127
    v_cvt_pk_bf16_f32 v138, v112, v113
    v_cvt_pk_bf16_f32 v139, v114, v115
    s_waitcnt lgkmcnt(3)
    v_mfma_f32_16x16x32_bf16 v[152:155], a[96:99], a[244:247], v[152:155]
    ds_read_b128 v[212:215], v15 offset:52224
    v_permlane32_swap_b32 v132, v134
    v_mfma_f32_16x16x32_bf16 v[156:159], a[244:247], a[100:103], v[156:159]
    v_permlane32_swap_b32 v133, v135
    v_permlane16_swap_b32 v136, v138
    v_mfma_f32_16x16x32_bf16 v[144:147], a[104:107], a[248:251], v[144:147]
    v_permlane16_swap_b32 v137, v139
    ds_read_b128 a[240:243], v16 offset:0
    v_mfma_f32_16x16x32_bf16 v[148:151], a[248:251], a[108:111], v[148:151]
    buffer_load_dwordx4 v[36:39], v1, s[48:51], s30 offen offset:2048 sc1
    v_mfma_f32_16x16x32_bf16 v[152:155], a[104:107], a[252:255], v[152:155]
    s_add_u32 s25, s76, 278528
    s_add_u32 s26, s76, 417792
    v_mfma_f32_16x16x32_bf16 v[156:159], a[252:255], a[108:111], v[156:159]
    ds_read_b128 a[244:247], v16 offset:2048
    buffer_store_dwordx4 v[128:131], v222, s[48:51], s25 offen sc0 sc1
    buffer_store_dwordx4 v[132:135], v222, s[48:51], s26 offen sc0 sc1
    buffer_store_dwordx4 v[136:139], v223, s[48:51], s25 offen offset:2048 sc0 sc1
    s_waitcnt lgkmcnt(3)
    v_mfma_f32_16x16x32_bf16 v[144:147], a[112:115], v[200:203], v[144:147]
    ds_read_b128 a[248:251], v16 offset:1024
    ds_read_b128 a[252:255], v16 offset:3072
    v_mfma_f32_16x16x32_bf16 v[148:151], v[200:203], a[116:119], v[148:151]
    v_mfma_f32_16x16x32_bf16 v[152:155], a[112:115], v[204:207], v[152:155]
    v_mfma_f32_16x16x32_bf16 v[156:159], v[204:207], a[116:119], v[156:159]
    s_waitcnt vmcnt(23)
    ds_read_b128 v[200:203], v16 offset:16384
    v_mfma_f32_16x16x32_bf16 v[144:147], a[120:123], v[208:211], v[144:147]
    s_waitcnt vmcnt(8)
    v_cmp_ne_u32 vcc, s9, v18
    v_mfma_f32_16x16x32_bf16 v[148:151], v[208:211], a[124:127], v[148:151]
    s_nop 0
    s_cbranch_vccnz L_plp8
L_pok7:
    buffer_load_dwordx4 v[40:43], v1, s[48:51], s30 offen offset:3072 sc1
    s_waitcnt lgkmcnt(3)
    v_mfma_f32_16x16x32_bf16 v[152:155], a[120:123], v[212:215], v[152:155]
    ds_read_b128 v[204:207], v16 offset:18432
    ds_read_b128 v[208:211], v16 offset:17408
    v_mfma_f32_16x16x32_bf16 v[156:159], v[212:215], a[124:127], v[156:159]
    v_mfma_f32_16x16x32_bf16 v[144:147], a[128:131], a[240:243], v[144:147]
    ds_read_b128 v[212:215], v16 offset:19456
    v_mfma_f32_16x16x32_bf16 v[148:151], a[240:243], a[132:135], v[148:151]
    v_mfma_f32_16x16x32_bf16 v[152:155], a[128:131], a[244:247], v[152:155]
    v_mfma_f32_16x16x32_bf16 v[156:159], a[244:247], a[132:135], v[156:159]
    s_waitcnt lgkmcnt(3)
    ds_read_b128 a[240:243], v1 offset:4096
    v_mfma_f32_16x16x32_bf16 v[144:147], a[136:139], a[248:251], v[144:147]
    buffer_load_dwordx4 v[44:47], v224, s[48:51], s30 offen offset:0 sc1
    v_mfma_f32_16x16x32_bf16 v[148:151], a[248:251], a[140:143], v[148:151]
    ds_read_b128 a[244:247], v1 offset:6144
    v_mfma_f32_16x16x32_bf16 v[152:155], a[136:139], a[252:255], v[152:155]
    ds_read_b128 a[248:251], v1 offset:5120
    v_mfma_f32_16x16x32_bf16 v[156:159], a[252:255], a[140:143], v[156:159]
    v_mfma_f32_16x16x32_bf16 v[144:147], a[144:147], v[200:203], v[144:147]
    v_mfma_f32_16x16x32_bf16 v[148:151], v[200:203], a[148:151], v[148:151]
    s_waitcnt lgkmcnt(3)
    ds_read_b128 a[252:255], v1 offset:7168
    v_mfma_f32_16x16x32_bf16 v[152:155], a[144:147], v[204:207], v[152:155]
    ds_read_b128 v[200:203], v1 offset:20480
    v_mfma_f32_16x16x32_bf16 v[156:159], v[204:207], a[148:151], v[156:159]
    s_add_u32 s30, s80, 10240
    v_mfma_f32_16x16x32_bf16 v[144:147], a[152:155], v[208:211], v[144:147]
    buffer_load_dwordx4 v[48:51], v1, s[48:51], s30 offen offset:0 sc1
    v_mfma_f32_16x16x32_bf16 v[148:151], v[208:211], a[156:159], v[148:151]
    ds_read_b128 v[204:207], v1 offset:22528
    v_mfma_f32_16x16x32_bf16 v[152:155], a[152:155], v[212:215], v[152:155]
    v_mfma_f32_16x16x32_bf16 v[156:159], v[212:215], a[156:159], v[156:159]
    s_waitcnt lgkmcnt(3)
    ds_read_b128 v[208:211], v1 offset:21504
    v_mfma_f32_16x16x32_bf16 v[160:163], a[0:3], a[240:243], 0
    v_mfma_f32_16x16x32_bf16 v[164:167], a[240:243], a[4:7], 0
    s_barrier
    ds_read_b128 v[212:215], v1 offset:23552
    v_mfma_f32_16x16x32_bf16 v[168:171], a[0:3], a[244:247], 0
    s_cmp_ge_u32 s4, 2
    s_cselect_b32 s13, s65, s64
    v_mfma_f32_16x16x32_bf16 v[172:175], a[244:247], a[4:7], 0
    s_add_u32 m0, s10, 81920
    v_mfma_f32_16x16x32_bf16 v[160:163], a[8:11], a[248:251], v[160:163]
    buffer_load_dwordx4 v17, s[60:63], s13 offen sc1 lds
    v_mfma_f32_16x16x32_bf16 v[164:167], a[248:251], a[12:15], v[164:167]
    ds_read_b128 a[240:243], v1 offset:36864
    buffer_load_dwordx4 v[52:55], v1, s[48:51], s30 offen offset:1024 sc1
    v_cvt_pk_bf16_f32 v144, v144, v145
    s_waitcnt lgkmcnt(3)
    v_mfma_f32_16x16x32_bf16 v[168:171], a[8:11], a[252:255], v[168:171]
    ds_read_b128 a[244:247], v1 offset:38912
    v_cvt_pk_bf16_f32 v145, v146, v147
    v_mfma_f32_16x16x32_bf16 v[172:175], a[252:255], a[12:15], v[172:175]
    ds_write_b64 v29, v[144:145] offset:0
    s_cmp_ge_u32 s4, 2
    v_mfma_f32_16x16x32_bf16 v[160:163], a[16:19], v[200:203], v[160:163]
    s_cselect_b32 s13, s67, s66
    s_add_u32 m0, s10, 98304
    v_mfma_f32_16x16x32_bf16 v[164:167], v[200:203], a[20:23], v[164:167]
    buffer_load_dwordx4 v17, s[60:63], s13 offen sc1 lds
    v_mfma_f32_16x16x32_bf16 v[168:171], a[16:19], v[204:207], v[168:171]
    ds_read_b128 a[248:251], v1 offset:37888
    v_cvt_pk_bf16_f32 v148, v148, v149
    v_mfma_f32_16x16x32_bf16 v[172:175], v[204:207], a[20:23], v[172:175]
    v_cvt_pk_bf16_f32 v149, v150, v151
    ds_read_b128 a[252:255], v1 offset:39936
    ds_write_b64 v29, v[148:149] offset:512
    v_cvt_pk_bf16_f32 v152, v152, v153
    s_cmp_ge_u32 s4, 2
    s_cselect_b32 s13, s69, s68
    s_add_u32 m0, s10, 114688
    s_nop 0
    buffer_load_dwordx4 v17, s[60:63], s13 offen sc1 lds
    s_waitcnt lgkmcnt(5)
    v_mfma_f32_16x16x32_bf16 v[160:163], a[24:27], v[208:211], v[160:163]
    ds_read_b128 v[200:203], v1 offset:53248
    v_cvt_pk_bf16_f32 v153, v154, v155
    v_mfma_f32_16x16x32_bf16 v[164:167], v[208:211], a[28:31], v[164:167]
    buffer_load_dwordx4 v[56:59], v1, s[48:51], s30 offen offset:2048 sc1
    v_mfma_f32_16x16x32_bf16 v[168:171], a[24:27], v[212:215], v[168:171]
    ds_write_b64 v29, v[152:153] offset:16384
    ds_read_b128 v[204:207], v1 offset:55296
    v_mfma_f32_16x16x32_bf16 v[172:175], v[212:215], a[28:31], v[172:175]
    v_cvt_pk_bf16_f32 v156, v156, v157
    v_cvt_pk_bf16_f32 v157, v158, v159
    v_mfma_f32_16x16x32_bf16 v[160:163], a[32:35], a[240:243], v[160:163]
    s_cmp_ge_u32 s4, 2
    s_cselect_b32 s13, s71, s70
    v_mfma_f32_16x16x32_bf16 v[164:167], a[240:243], a[36:39], v[164:167]
    s_add_u32 m0, s10, 131072
    s_nop 0
    buffer_load_dwordx4 v17, s[60:63], s13 offen sc1 lds
    ds_read_b128 v[208:211], v1 offset:54272
    ds_write_b64 v29, v[156:157] offset:16896
    s_waitcnt lgkmcnt(6)
    v_mfma_f32_16x16x32_bf16 v[168:171], a[32:35], a[244:247], v[168:171]
    ds_read_b128 v[212:215], v1 offset:56320
    s_cmp_ge_u32 s4, 2
    v_mfma_f32_16x16x32_bf16 v[172:175], a[244:247], a[36:39], v[172:175]
    s_cselect_b32 s13, s73, s72
    s_add_u32 m0, s10, 147456
    v_mfma_f32_16x16x32_bf16 v[160:163], a[40:43], a[248:251], v[160:163]
    buffer_load_dwordx4 v17, s[60:63], s13 offen sc1 lds
    v_mfma_f32_16x16x32_bf16 v[164:167], a[248:251], a[44:47], v[164:167]
    ds_read_b128 a[240:243], v15 offset:4096
    v_mfma_f32_16x16x32_bf16 v[168:171], a[40:43], a[252:255], v[168:171]
    buffer_load_dwordx4 v[128:131], v1, s[48:51], s30 offen offset:3072 sc1
    v_mfma_f32_16x16x32_bf16 v[172:175], a[252:255], a[44:47], v[172:175]
    ds_read_b128 a[244:247], v15 offset:6144
    s_waitcnt lgkmcnt(4)
    v_mfma_f32_16x16x32_bf16 v[160:163], a[48:51], v[200:203], v[160:163]
    ds_read_b128 a[248:251], v15 offset:5120
    ds_read_b128 a[252:255], v15 offset:7168
    v_mfma_f32_16x16x32_bf16 v[164:167], v[200:203], a[52:55], v[164:167]
    v_mfma_f32_16x16x32_bf16 v[168:171], a[48:51], v[204:207], v[168:171]
    ds_read_b128 v[200:203], v15 offset:20480
    v_mfma_f32_16x16x32_bf16 v[172:175], v[204:207], a[52:55], v[172:175]
    buffer_load_dwordx4 v[132:135], v224, s[48:51], s30 offen offset:0 sc1
    v_mfma_f32_16x16x32_bf16 v[160:163], a[56:59], v[208:211], v[160:163]
    v_mfma_f32_16x16x32_bf16 v[164:167], v[208:211], a[60:63], v[164:167]
    s_waitcnt lgkmcnt(3)
    ds_read_b128 v[204:207], v15 offset:22528
    v_mfma_f32_16x16x32_bf16 v[168:171], a[56:59], v[212:215], v[168:171]
    ds_read_b128 v[208:211], v15 offset:21504
    v_mfma_f32_16x16x32_bf16 v[172:175], v[212:215], a[60:63], v[172:175]
    v_mfma_f32_16x16x32_bf16 v[160:163], a[64:67], a[240:243], v[160:163]
    ds_read_b128 v[212:215], v15 offset:23552
    v_mfma_f32_16x16x32_bf16 v[164:167], a[240:243], a[68:71], v[164:167]
    v_mfma_f32_16x16x32_bf16 v[168:171], a[64:67], a[244:247], v[168:171]
    v_mfma_f32_16x16x32_bf16 v[172:175], a[244:247], a[68:71], v[172:175]
    s_waitcnt lgkmcnt(3)
    ds_read_b128 a[240:243], v15 offset:36864
    v_mfma_f32_16x16x32_bf16 v[160:163], a[72:75], a[248:251], v[160:163]
    ds_read_b128 a[244:247], v15 offset:38912
    s_add_u32 s30, s80, 15360
    v_mfma_f32_16x16x32_bf16 v[164:167], a[248:251], a[76:79], v[164:167]
    buffer_load_dwordx4 v[136:139], v1, s[48:51], s30 offen offset:0 sc1
    v_mfma_f32_16x16x32_bf16 v[168:171], a[72:75], a[252:255], v[168:171]
    ds_read_b128 a[248:251], v15 offset:37888
    v_mfma_f32_16x16x32_bf16 v[172:175], a[252:255], a[76:79], v[172:175]
    v_mfma_f32_16x16x32_bf16 v[160:163], a[80:83], v[200:203], v[160:163]
    s_waitcnt vmcnt(13)
    s_barrier
    v_mfma_f32_16x16x32_bf16 v[164:167], v[200:203], a[84:87], v[164:167]
    s_mov_b64 exec, 1
    buffer_store_dword v30, v28, s[48:51], s85 offen offset:256 sc0 sc1
    s_mov_b64 exec, -1
    s_lshl_b32 s24, s7, 2
    s_add_u32 s24, s24, s4
    s_waitcnt lgkmcnt(3)
    v_mfma_f32_16x16x32_bf16 v[168:171], a[80:83], v[204:207], v[168:171]
    ds_read_b128 a[252:255], v15 offset:39936
    s_mul_i32 s24, s24, 69632
    v_mfma_f32_16x16x32_bf16 v[172:175], v[204:207], a[84:87], v[172:175]
    s_add_u32 s24, s24, 2699264
    s_lshl_b32 s12, s7, 6
    v_mfma_f32_16x16x32_bf16 v[160:163], a[88:91], v[208:211], v[160:163]
    ds_read_b128 v[200:203], v15 offset:53248
    s_lshr_b32 s14, s4, 1
    v_mfma_f32_16x16x32_bf16 v[164:167], v[208:211], a[92:95], v[164:167]
    s_lshl_b32 s14, s14, 5
    ds_read_b128 v[204:207], v15 offset:55296
    v_mfma_f32_16x16x32_bf16 v[168:171], a[88:91], v[212:215], v[168:171]
    buffer_load_dwordx4 v[140:143], v1, s[48:51], s30 offen offset:1024 sc1
    v_mfma_f32_16x16x32_bf16 v[172:175], v[212:215], a[92:95], v[172:175]
    s_add_u32 s12, s12, s14
    s_and_b32 s14, s4, 1
    s_waitcnt lgkmcnt(3)
    v_mfma_f32_16x16x32_bf16 v[160:163], a[96:99], a[240:243], v[160:163]
    ds_read_b128 v[208:211], v15 offset:54272
    s_add_u32 s12, s12, s14
    v_mfma_f32_16x16x32_bf16 v[164:167], a[240:243], a[100:103], v[164:167]
    s_mul_i32 s12, s12, 1280
    ds_read_b128 v[212:215], v15 offset:56320
    v_mfma_f32_16x16x32_bf16 v[168:171], a[96:99], a[244:247], v[168:171]
    s_mul_i32 s14, s8, 160
    s_add_u32 s76, s12, s14
    v_mfma_f32_16x16x32_bf16 v[172:175], a[244:247], a[100:103], v[172:175]
    v_add_u32 v21, 0, v20
    ds_read_b128 a[240:243], v16 offset:4096
    v_mfma_f32_16x16x32_bf16 v[160:163], a[104:107], a[248:251], v[160:163]
    v_mul_u32_u24 v22, 0x199a, v21
    v_lshrrev_b32 v22, 16, v22
    v_mfma_f32_16x16x32_bf16 v[164:167], a[248:251], a[108:111], v[164:167]
    s_waitcnt lgkmcnt(3)
    ds_read_b128 a[244:247], v16 offset:6144
    v_mfma_f32_16x16x32_bf16 v[168:171], a[104:107], a[252:255], v[168:171]
    buffer_load_dwordx4 v[124:127], v1, s[48:51], s30 offen offset:2048 sc1
    v_mfma_f32_16x16x32_bf16 v[172:175], a[252:255], a[108:111], v[172:175]
    v_mul_u32_u24 v22, 2400, v22
    v_lshl_add_u32 v2, v21, 4, v22
    v_mfma_f32_16x16x32_bf16 v[160:163], a[112:115], v[200:203], v[160:163]
    ds_read_b128 a[248:251], v16 offset:5120
    v_add_u32 v21, 64, v20
    v_mfma_f32_16x16x32_bf16 v[164:167], v[200:203], a[116:119], v[164:167]
    v_mul_u32_u24 v22, 0x199a, v21
    ds_read_b128 a[252:255], v16 offset:7168
    v_mfma_f32_16x16x32_bf16 v[168:171], a[112:115], v[204:207], v[168:171]
    v_lshrrev_b32 v22, 16, v22
    v_mul_u32_u24 v22, 2400, v22
    v_mfma_f32_16x16x32_bf16 v[172:175], v[204:207], a[116:119], v[172:175]
    v_lshl_add_u32 v3, v21, 4, v22
    s_waitcnt lgkmcnt(3)
    v_mfma_f32_16x16x32_bf16 v[160:163], a[120:123], v[208:211], v[160:163]
    ds_read_b128 v[200:203], v16 offset:20480
    v_add_u32 v21, 128, v20
    v_mfma_f32_16x16x32_bf16 v[164:167], v[208:211], a[124:127], v[164:167]
    v_mul_u32_u24 v22, 0x199a, v21
    ds_read_b128 v[204:207], v16 offset:22528
    v_mfma_f32_16x16x32_bf16 v[168:171], a[120:123], v[212:215], v[168:171]
    buffer_load_dwordx4 a[188:191], v1, s[48:51], s30 offen offset:3072 sc1
    v_mfma_f32_16x16x32_bf16 v[172:175], v[212:215], a[124:127], v[172:175]
    v_lshrrev_b32 v22, 16, v22
    v_mul_u32_u24 v22, 2400, v22
    v_mfma_f32_16x16x32_bf16 v[160:163], a[128:131], a[240:243], v[160:163]
    ds_read_b128 v[208:211], v16 offset:21504
    v_lshl_add_u32 v4, v21, 4, v22
    v_mfma_f32_16x16x32_bf16 v[164:167], a[240:243], a[132:135], v[164:167]
    v_lshrrev_b32 v21, 5, v20
    s_waitcnt lgkmcnt(3)
    v_mfma_f32_16x16x32_bf16 v[168:171], a[128:131], a[244:247], v[168:171]
    ds_read_b128 v[212:215], v16 offset:23552
    v_lshl_add_u32 v4, v21, 30, v4
    v_mfma_f32_16x16x32_bf16 v[172:175], a[244:247], a[132:135], v[172:175]
    s_lshl_b32 s12, s4, 14
    v_and_b32 v21, 15, v20
    v_mfma_f32_16x16x32_bf16 v[160:163], a[136:139], a[248:251], v[160:163]
    s_waitcnt vmcnt(7)
    s_barrier
    v_mfma_f32_16x16x32_bf16 v[164:167], a[248:251], a[140:143], v[164:167]
    ds_read_b128 a[240:243], v15 offset:16384
    v_mul_u32_u24 v21, 160, v21
    v_mfma_f32_16x16x32_bf16 v[168:171], a[136:139], a[252:255], v[168:171]
    v_lshrrev_b32 v22, 4, v20
    ds_read_b128 a[244:247], v15 offset:17408
    v_mfma_f32_16x16x32_bf16 v[172:175], a[252:255], a[140:143], v[172:175]
    buffer_load_dwordx4 a[192:195], v224, s[48:51], s30 offen offset:0 sc1
    v_lshl_add_u32 v21, v22, 3, v21
    v_add_u32 v5, s12, v21
    s_waitcnt lgkmcnt(3)
    v_mfma_f32_16x16x32_bf16 v[160:163], a[144:147], v[200:203], v[160:163]
    ds_read_b128 a[248:251], v15 offset:18432
    v_add_u32 v6, s12, v1
    v_mfma_f32_16x16x32_bf16 v[164:167], v[200:203], a[148:151], v[164:167]
    s_add_u32 s14, s4, 0
    ds_read_b128 a[252:255], v15 offset:19456
    v_mfma_f32_16x16x32_bf16 v[168:171], a[144:147], v[204:207], v[168:171]
    s_and_b32 s14, s14, 3
    s_lshl_b32 s14, s14, 10
    v_mfma_f32_16x16x32_bf16 v[172:175], v[204:207], a[148:151], v[172:175]
    v_add_u32 v7, s14, v1
    ds_read_b128 v[200:203], v15 offset:32768
    v_mfma_f32_16x16x32_bf16 v[160:163], a[152:155], v[208:211], v[160:163]
    v_add_u32 v8, s14, v15
    v_add_u32 v9, s14, v16
    v_mfma_f32_16x16x32_bf16 v[164:167], v[208:211], a[156:159], v[164:167]
    s_waitcnt lgkmcnt(3)
    ds_read_b128 v[204:207], v15 offset:33792
    v_mfma_f32_16x16x32_bf16 v[168:171], a[152:155], v[212:215], v[168:171]
    s_add_u32 s14, s4, 1
    s_add_u32 s30, s80, 20480
    v_mfma_f32_16x16x32_bf16 v[172:175], v[212:215], a[156:159], v[172:175]
    buffer_load_dwordx4 a[196:199], v1, s[48:51], s30 offen offset:0 sc1
    v_mfma_f32_16x16x32_bf16 v[64:67], a[0:3], a[240:243], 0
    s_and_b32 s14, s14, 3
    ds_read_b128 v[208:211], v15 offset:34816
    v_mfma_f32_16x16x32_bf16 v[68:71], a[240:243], a[4:7], 0
    s_lshl_b32 s14, s14, 10
    v_add_u32 v10, s14, v1
    v_mfma_f32_16x16x32_bf16 v[64:67], a[8:11], a[244:247], v[64:67]
    ds_read_b128 v[212:215], v15 offset:35840
    v_add_u32 v11, s14, v15
    v_mfma_f32_16x16x32_bf16 v[68:71], a[244:247], a[12:15], v[68:71]
    s_add_u32 s14, s4, 2
    s_and_b32 s14, s14, 3
    s_waitcnt lgkmcnt(3)
    v_mfma_f32_16x16x32_bf16 v[64:67], a[16:19], a[248:251], v[64:67]
    ds_read_b128 a[240:243], v15 offset:49152
    v_cvt_pk_bf16_f32 v160, v160, v161
    v_mfma_f32_16x16x32_bf16 v[68:71], a[248:251], a[20:23], v[68:71]
    v_cvt_pk_bf16_f32 v161, v162, v163
    ds_read_b128 a[244:247], v15 offset:50176
    v_mfma_f32_16x16x32_bf16 v[64:67], a[24:27], a[252:255], v[64:67]
    ds_write_b64 v29, v[160:161] offset:32768
    v_mfma_f32_16x16x32_bf16 v[68:71], a[252:255], a[28:31], v[68:71]
    buffer_load_dwordx4 a[200:203], v1, s[48:51], s30 offen offset:1024 sc1
    v_mfma_f32_16x16x32_bf16 v[64:67], a[32:35], v[200:203], v[64:67]
    v_cvt_pk_bf16_f32 v164, v164, v165
    s_lshl_b32 s14, s14, 10
    v_mfma_f32_16x16x32_bf16 v[68:71], v[200:203], a[36:39], v[68:71]
    ds_read_b128 a[248:251], v15 offset:51200
    v_cvt_pk_bf16_f32 v165, v166, v167
    ds_write_b64 v29, v[164:165] offset:33280
    s_waitcnt lgkmcnt(5)
    v_mfma_f32_16x16x32_bf16 v[64:67], a[40:43], v[204:207], v[64:67]
    ds_read_b128 a[252:255], v15 offset:52224
    v_cvt_pk_bf16_f32 v168, v168, v169
    v_mfma_f32_16x16x32_bf16 v[68:71], v[204:207], a[44:47], v[68:71]
    v_cvt_pk_bf16_f32 v169, v170, v171
    v_add_u32 v12, s14, v1
    v_mfma_f32_16x16x32_bf16 v[64:67], a[48:51], v[208:211], v[64:67]
    ds_read_b128 v[200:203], v16 offset:0
    ds_write_b64 v29, v[168:169] offset:49152
    v_mfma_f32_16x16x32_bf16 v[68:71], v[208:211], a[52:55], v[68:71]
    v_cvt_pk_bf16_f32 v172, v172, v173
    ds_read_b128 v[204:207], v16 offset:1024
    v_mfma_f32_16x16x32_bf16 v[64:67], a[56:59], v[212:215], v[64:67]
    v_cvt_pk_bf16_f32 v173, v174, v175
    v_mfma_f32_16x16x32_bf16 v[68:71], v[212:215], a[60:63], v[68:71]
    buffer_load_dwordx4 a[204:207], v1, s[48:51], s30 offen offset:2048 sc1
    ds_write_b64 v29, v[172:173] offset:49664
    v_add_u32 v13, s14, v15
    s_waitcnt lgkmcnt(6)
    v_mfma_f32_16x16x32_bf16 v[64:67], a[64:67], a[240:243], v[64:67]
    ds_read_b128 v[208:211], v16 offset:2048
    s_add_u32 s14, s4, 3
    v_mfma_f32_16x16x32_bf16 v[68:71], a[240:243], a[68:71], v[68:71]
    s_and_b32 s14, s14, 3
    ds_read_b128 v[212:215], v16 offset:3072
    v_mfma_f32_16x16x32_bf16 v[64:67], a[72:75], a[244:247], v[64:67]
    s_lshl_b32 s14, s14, 10
    v_add_u32 v14, s14, v15
    v_mfma_f32_16x16x32_bf16 v[68:71], a[244:247], a[76:79], v[68:71]
    v_add_u32 v17, s14, v16
    ds_read_b128 a[240:243], v16 offset:16384
    v_mfma_f32_16x16x32_bf16 v[64:67], a[80:83], a[248:251], v[64:67]
    buffer_load_dword v18, v220, s[48:51], 0 offen sc0 sc1
    v_mfma_f32_16x16x32_bf16 v[68:71], a[248:251], a[84:87], v[68:71]
    s_waitcnt lgkmcnt(4)
    ds_read_b128 a[244:247], v16 offset:17408
    v_mfma_f32_16x16x32_bf16 v[64:67], a[88:91], a[252:255], v[64:67]
    buffer_load_dwordx4 a[208:211], v1, s[48:51], s30 offen offset:3072 sc1
    v_mfma_f32_16x16x32_bf16 v[68:71], a[252:255], a[92:95], v[68:71]
    ds_read_b128 a[248:251], v16 offset:18432
    v_mfma_f32_16x16x32_bf16 v[64:67], a[96:99], v[200:203], v[64:67]
    ds_read_b128 a[252:255], v16 offset:19456
    v_mfma_f32_16x16x32_bf16 v[68:71], v[200:203], a[100:103], v[68:71]
    v_mfma_f32_16x16x32_bf16 v[64:67], a[104:107], v[204:207], v[64:67]
    v_mfma_f32_16x16x32_bf16 v[68:71], v[204:207], a[108:111], v[68:71]
    s_waitcnt lgkmcnt(3)
    ds_read_b128 v[200:203], v1 offset:8192
    v_mfma_f32_16x16x32_bf16 v[64:67], a[112:115], v[208:211], v[64:67]
    ds_read_b128 v[204:207], v1 offset:10240
    v_mfma_f32_16x16x32_bf16 v[68:71], v[208:211], a[116:119], v[68:71]
    buffer_load_dwordx4 a[212:215], v224, s[48:51], s30 offen offset:0 sc1
    v_mfma_f32_16x16x32_bf16 v[64:67], a[120:123], v[212:215], v[64:67]
    ds_read_b128 v[208:211], v1 offset:12288
    v_mfma_f32_16x16x32_bf16 v[68:71], v[212:215], a[124:127], v[68:71]
    v_mfma_f32_16x16x32_bf16 v[64:67], a[128:131], a[240:243], v[64:67]
    v_mfma_f32_16x16x32_bf16 v[68:71], a[240:243], a[132:135], v[68:71]
    s_waitcnt lgkmcnt(3)
    ds_read_b128 v[212:215], v1 offset:14336
    v_mfma_f32_16x16x32_bf16 v[64:67], a[136:139], a[244:247], v[64:67]
    ds_read_b128 a[240:243], v1 offset:9216
    v_mfma_f32_16x16x32_bf16 v[68:71], a[244:247], a[140:143], v[68:71]
    v_mfma_f32_16x16x32_bf16 v[64:67], a[144:147], a[248:251], v[64:67]
    ds_read_b128 a[244:247], v1 offset:11264
    v_mfma_f32_16x16x32_bf16 v[68:71], a[248:251], a[148:151], v[68:71]
    v_mfma_f32_16x16x32_bf16 v[64:67], a[152:155], a[252:255], v[64:67]
    v_mfma_f32_16x16x32_bf16 v[68:71], a[252:255], a[156:159], v[68:71]
    s_waitcnt lgkmcnt(3)
    ds_read_b128 a[248:251], v1 offset:13312
    v_mfma_f32_16x16x32_bf16 v[144:147], a[0:3], v[200:203], 0
    ds_read_b128 a[252:255], v1 offset:15360
    v_mfma_f32_16x16x32_bf16 v[148:151], v[200:203], a[4:7], 0
    v_mfma_f32_16x16x32_bf16 v[152:155], a[0:3], v[204:207], 0
    ds_read_b128 v[200:203], v1 offset:24576
    v_cvt_pk_bf16_f32 v64, v64, v65
    v_mfma_f32_16x16x32_bf16 v[156:159], v[204:207], a[4:7], 0
    v_cvt_pk_bf16_f32 v65, v66, v67
    v_mfma_f32_16x16x32_bf16 v[160:163], a[0:3], v[208:211], 0
    v_mfma_f32_16x16x32_bf16 v[164:167], v[208:211], a[4:7], 0
    s_waitcnt lgkmcnt(3)
    ds_read_b128 v[204:207], v1 offset:26624
    v_mfma_f32_16x16x32_bf16 v[168:171], a[0:3], v[212:215], 0
    ds_write_b64 v254, v[64:65] offset:0
    v_cvt_pk_bf16_f32 v68, v68, v69
    v_mfma_f32_16x16x32_bf16 v[172:175], v[212:215], a[4:7], 0
    ds_read_b128 v[208:211], v1 offset:28672
    v_cvt_pk_bf16_f32 v69, v70, v71
    v_mfma_f32_16x16x32_bf16 v[144:147], a[8:11], a[240:243], v[144:147]
    ds_write_b64 v254, v[68:69] offset:512
    ds_read_b128 v[212:215], v1 offset:30720
    v_mfma_f32_16x16x32_bf16 v[148:151], a[240:243], a[12:15], v[148:151]
    v_mfma_f32_16x16x32_bf16 v[152:155], a[8:11], a[244:247], v[152:155]
    v_mfma_f32_16x16x32_bf16 v[156:159], a[244:247], a[12:15], v[156:159]
    s_waitcnt lgkmcnt(5)
    ds_read_b128 a[240:243], v1 offset:25600
    v_mfma_f32_16x16x32_bf16 v[160:163], a[8:11], a[248:251], v[160:163]
    ds_read_b128 a[244:247], v1 offset:27648
    v_mfma_f32_16x16x32_bf16 v[164:167], a[248:251], a[12:15], v[164:167]
    v_mfma_f32_16x16x32_bf16 v[168:171], a[8:11], a[252:255], v[168:171]
    ds_read_b128 a[248:251], v1 offset:29696
    v_mfma_f32_16x16x32_bf16 v[172:175], a[252:255], a[12:15], v[172:175]
    v_mfma_f32_16x16x32_bf16 v[144:147], a[16:19], v[200:203], v[144:147]
    s_waitcnt lgkmcnt(4)
    s_barrier
    v_mfma_f32_16x16x32_bf16 v[148:151], v[200:203], a[20:23], v[148:151]
    ds_read_b64 v[80:81], v229 offset:0
    ds_read_b64_tr_b16 v[82:83], v233 offset:3584
    v_mfma_f32_16x16x32_bf16 v[152:155], a[16:19], v[204:207], v[152:155]
    ds_read_b128 a[252:255], v1 offset:31744
    s_mov_b32 s83, 0
    v_mfma_f32_16x16x32_bf16 v[156:159], v[204:207], a[20:23], v[156:159]
    s_add_u32 m0, s10, 69632
    v_mfma_f32_16x16x32_bf16 v[160:163], a[16:19], v[208:211], v[160:163]
    buffer_load_dwordx4 v19, s[48:51], s83 offen sc1 lds
    v_mfma_f32_16x16x32_bf16 v[164:167], v[208:211], a[20:23], v[164:167]
    ds_read_b64 a[160:161], v229 offset:2048
    ds_read_b64_tr_b16 a[162:163], v233 offset:3648
    ds_read_b128 v[200:203], v1 offset:40960
    s_waitcnt vmcnt(3)
    v_cmp_ne_u32 vcc, s9, v18
    s_nop 1
    s_cbranch_vccnz L_plp10
L_pok9:
    ds_read_b64 a[168:169], v231 offset:2048
    s_waitcnt lgkmcnt(8)
    v_mfma_f32_16x16x32_bf16 v[168:171], a[16:19], v[212:215], v[168:171]
    ds_read_b128 v[204:207], v1 offset:43008
    s_add_u32 s31, s81, 0
    v_mfma_f32_16x16x32_bf16 v[172:175], v[212:215], a[20:23], v[172:175]
    buffer_load_dwordx4 a[216:219], v225, s[48:51], s31 offen offset:0 sc1
    v_mfma_f32_16x16x32_bf16 v[144:147], a[24:27], a[240:243], v[144:147]
    ds_read_b64_tr_b16 a[170:171], v250 offset:3648
    ds_read_b64 v[84:85], v229 offset:1024
    v_mfma_f32_16x16x32_bf16 v[148:151], a[240:243], a[28:31], v[148:151]
    ds_read_b128 v[208:211], v1 offset:45056
    ds_read_b64_tr_b16 v[86:87], v233 offset:3616
    v_mfma_f32_16x16x32_bf16 v[152:155], a[24:27], a[244:247], v[152:155]
    buffer_load_dwordx4 a[220:223], v226, s[48:51], s31 offen offset:0 sc1
    v_mfma_f32_16x16x32_bf16 v[156:159], a[244:247], a[28:31], v[156:159]
    ds_read_b128 v[212:215], v1 offset:47104
    ds_read_b64 a[164:165], v229 offset:3072
    ds_read_b64_tr_b16 a[166:167], v233 offset:3680
    ds_read_b64 a[172:173], v231 offset:3072
    s_waitcnt lgkmcnt(10)
    v_mfma_f32_16x16x32_bf16 v[160:163], a[24:27], a[248:251], v[160:163]
    ds_read_b128 a[240:243], v1 offset:41984
    ds_read_b64_tr_b16 a[174:175], v250 offset:3680
    v_mfma_f32_16x16x32_bf16 v[164:167], a[248:251], a[28:31], v[164:167]
    buffer_load_dwordx4 a[224:227], v227, s[48:51], s31 offen offset:0 sc1
    v_mfma_f32_16x16x32_bf16 v[168:171], a[24:27], a[252:255], v[168:171]
    ds_read_b128 a[244:247], v1 offset:44032
    s_waitcnt lgkmcnt(10)
    v_mfma_f32_16x16x32_bf16 v[172:175], a[252:255], a[28:31], v[172:175]
    v_and_b32 v82, v82, v235
    v_and_b32 v83, v83, v235
    v_mfma_f32_16x16x32_bf16 v[144:147], a[32:35], v[200:203], v[144:147]
    s_waitcnt lgkmcnt(1)
    v_and_b32 v86, v86, v235
    v_mfma_f32_16x16x32_bf16 v[148:151], v[200:203], a[36:39], v[148:151]
    ds_read_b128 a[248:251], v1 offset:46080
    v_and_b32 v87, v87, v235
    v_mfma_f32_16x16x32_bf16 v[152:155], a[32:35], v[204:207], v[152:155]
    buffer_load_dwordx4 a[228:231], v228, s[48:51], s31 offen offset:0 sc1
    v_mfma_f32_16x16x32_bf16 v[156:159], v[204:207], a[36:39], v[156:159]
    ds_read_b128 a[252:255], v1 offset:48128
    ds_read_b64 a[186:187], v229 offset:2560
    v_mfma_f32_16x16x32_bf16 v[88:91], a[160:163], v[80:83], v[236:239]
    s_mov_b32 s83, 4096
    s_add_u32 m0, s10, 86016
    v_mfma_f32_16x16x32_bf16 v[160:163], a[32:35], v[208:211], v[160:163]
    buffer_load_dwordx4 v19, s[48:51], s83 offen sc1 lds
    v_mfma_f32_16x16x32_bf16 v[92:95], a[168:171], v[80:83], v[244:247]
    ds_read_b128 v[200:203], v1 offset:57344
    v_mfma_f32_16x16x32_bf16 v[164:167], v[208:211], a[36:39], v[164:167]
    buffer_load_dwordx4 a[232:235], v225, s[48:51], s31 offen offset:1024 sc1
    v_mfma_f32_16x16x32_bf16 v[168:171], a[32:35], v[212:215], v[168:171]
    ds_read_b128 v[204:207], v1 offset:59392
    v_mfma_f32_16x16x32_bf16 v[96:99], a[164:167], v[84:87], v[236:239]
    ds_read_b64 a[184:185], v231 offset:2560
    v_mfma_f32_16x16x32_bf16 v[172:175], v[212:215], a[36:39], v[172:175]
    ds_read_b128 v[208:211], v1 offset:61440
    v_mfma_f32_16x16x32_bf16 v[100:103], a[172:175], v[84:87], v[244:247]
    buffer_load_dwordx4 a[236:239], v226, s[48:51], s31 offen offset:1024 sc1
    v_mfma_f32_16x16x32_bf16 v[144:147], a[40:43], a[240:243], v[144:147]
    ds_read_b64 a[178:179], v229 offset:512
    v_mfma_f32_16x16x32_bf16 v[148:151], a[240:243], a[44:47], v[148:151]
    s_waitcnt lgkmcnt(6)
    ds_read_b128 v[212:215], v1 offset:63488
    v_mfma_f32_16x16x32_bf16 v[152:155], a[40:43], a[244:247], v[152:155]
    ds_read_b64 a[176:177], v231 offset:512
    ds_read_b64 a[182:183], v229 offset:1536
    v_mfma_f32_16x16x32_bf16 v[156:159], a[244:247], a[44:47], v[156:159]
    ds_read_b64 a[180:181], v231 offset:1536
    ds_read_b128 a[240:243], v1 offset:58368
    v_mfma_f32_16x16x32_bf16 v[160:163], a[40:43], a[248:251], v[160:163]
    buffer_load_dwordx4 a[0:3], v227, s[48:51], s31 offen offset:1024 sc1
    v_mfma_f32_16x16x32_bf16 v[164:167], a[248:251], a[44:47], v[164:167]
    v_max_f32 v88, v88, v92
    ds_read_b128 a[244:247], v1 offset:60416
    v_mfma_f32_16x16x32_bf16 v[168:171], a[40:43], a[252:255], v[168:171]
    v_max_f32 v89, v89, v93
    v_max_f32 v90, v90, v94
    v_mfma_f32_16x16x32_bf16 v[172:175], a[252:255], a[44:47], v[172:175]
    v_max_f32 v91, v91, v95
    s_waitcnt lgkmcnt(7)
    v_mfma_f32_16x16x32_bf16 v[144:147], a[48:51], v[200:203], v[144:147]
    ds_read_b128 a[248:251], v1 offset:62464
    v_mfma_f32_16x16x32_bf16 v[148:151], v[200:203], a[52:55], v[148:151]
    buffer_load_dwordx4 a[4:7], v228, s[48:51], s31 offen offset:1024 sc1
    v_mfma_f32_16x16x32_bf16 v[152:155], a[48:51], v[204:207], v[152:155]
    v_max_f32 v96, v96, v100
    ds_read_b128 a[252:255], v1 offset:64512
    v_mfma_f32_16x16x32_bf16 v[156:159], v[204:207], a[52:55], v[156:159]
    v_max_f32 v97, v97, v101
    v_max_f32 v98, v98, v102
    v_mfma_f32_16x16x32_bf16 v[160:163], a[48:51], v[208:211], v[160:163]
    v_max_f32 v99, v99, v103
    ds_read_b128 v[200:203], v15 offset:8192
    v_mfma_f32_16x16x32_bf16 v[164:167], v[208:211], a[52:55], v[164:167]
    buffer_load_dwordx4 a[8:11], v225, s[48:51], s31 offen offset:2048 sc1
    s_mov_b32 s83, 8192
    s_add_u32 m0, s10, 102400
    s_nop 0
    buffer_load_dwordx4 v19, s[48:51], s83 offen sc1 lds
    s_waitcnt lgkmcnt(3)
    v_mfma_f32_16x16x32_bf16 v[168:171], a[48:51], v[212:215], v[168:171]
    ds_read_b128 v[204:207], v15 offset:10240
    v_cvt_pk_bf16_f32 v88, 0, v88
    v_mfma_f32_16x16x32_bf16 v[172:175], v[212:215], a[52:55], v[172:175]
    v_cvt_pk_bf16_f32 v89, 0, v89
    v_cvt_pk_bf16_f32 v90, 0, v90
    v_mfma_f32_16x16x32_bf16 v[144:147], a[56:59], a[240:243], v[144:147]
    ds_read_b128 v[208:211], v15 offset:12288
    v_mfma_f32_16x16x32_bf16 v[148:151], a[240:243], a[60:63], v[148:151]
    buffer_load_dwordx4 a[12:15], v226, s[48:51], s31 offen offset:2048 sc1
    v_mfma_f32_16x16x32_bf16 v[152:155], a[56:59], a[244:247], v[152:155]
    v_cvt_pk_bf16_f32 v91, 0, v91
    ds_read_b128 v[212:215], v15 offset:14336
    v_mfma_f32_16x16x32_bf16 v[156:159], a[244:247], a[60:63], v[156:159]
    v_cvt_pk_bf16_f32 v96, 0, v96
    buffer_load_dwordx4 a[16:19], v227, s[48:51], s31 offen offset:2048 sc1
    v_cvt_pk_bf16_f32 v97, 0, v97
    s_waitcnt lgkmcnt(3)
    v_mfma_f32_16x16x32_bf16 v[160:163], a[56:59], a[248:251], v[160:163]
    ds_read_b128 a[240:243], v15 offset:9216
    v_cvt_pk_bf16_f32 v98, 0, v98
    v_mfma_f32_16x16x32_bf16 v[164:167], a[248:251], a[60:63], v[164:167]
    v_cvt_pk_bf16_f32 v99, 0, v99
    ds_read_b128 a[244:247], v15 offset:11264
    v_mfma_f32_16x16x32_bf16 v[168:171], a[56:59], a[252:255], v[168:171]
    v_mul_f32 v88, 0x3e64f92e, v88
    v_mfma_f32_16x16x32_bf16 v[172:175], a[252:255], a[60:63], v[172:175]
    buffer_load_dwordx4 a[20:23], v228, s[48:51], s31 offen offset:2048 sc1
    v_mfma_f32_16x16x32_bf16 v[144:147], a[64:67], v[200:203], v[144:147]
    v_mul_f32 v89, 0x3e64f92e, v89
    ds_read_b128 a[248:251], v15 offset:13312
    v_mfma_f32_16x16x32_bf16 v[148:151], v[200:203], a[68:71], v[148:151]
    v_mul_f32 v90, 0x3e64f92e, v90
    v_mul_f32 v91, 0x3e64f92e, v91
    s_waitcnt lgkmcnt(3)
    v_mfma_f32_16x16x32_bf16 v[152:155], a[64:67], v[204:207], v[152:155]
    ds_read_b128 a[252:255], v15 offset:15360
    s_barrier
    v_mfma_f32_16x16x32_bf16 v[156:159], v[204:207], a[68:71], v[156:159]
    buffer_load_dwordx4 a[24:27], v225, s[48:51], s31 offen offset:3072 sc1
    v_mfma_f32_16x16x32_bf16 v[160:163], a[64:67], v[208:211], v[160:163]
    v_mul_f32 v96, 0x3e64f92e, v96
    ds_read_b128 v[200:203], v15 offset:24576
    v_mfma_f32_16x16x32_bf16 v[164:167], v[208:211], a[68:71], v[164:167]
    v_mul_f32 v97, 0x3e64f92e, v97
    v_mul_f32 v98, 0x3e64f92e, v98
    v_mfma_f32_16x16x32_bf16 v[168:171], a[64:67], v[212:215], v[168:171]
    ds_read_b128 v[204:207], v15 offset:26624
    s_mov_b32 s83, 12288
    v_mfma_f32_16x16x32_bf16 v[172:175], v[212:215], a[68:71], v[172:175]
    s_add_u32 m0, s10, 118784
    s_nop 0
    buffer_load_dwordx4 v19, s[48:51], s83 offen sc1 lds
    buffer_load_dwordx4 a[28:31], v226, s[48:51], s31 offen offset:3072 sc1
    v_mul_f32 v99, 0x3e64f92e, v99
    s_waitcnt lgkmcnt(3)
    v_mfma_f32_16x16x32_bf16 v[144:147], a[72:75], a[240:243], v[144:147]
    ds_read_b128 v[208:211], v15 offset:28672
    v_cvt_pk_bf16_f32 v88, 0, v88
    v_mfma_f32_16x16x32_bf16 v[148:151], a[240:243], a[76:79], v[148:151]
    v_cvt_pk_bf16_f32 v89, 0, v89
    ds_read_b128 v[212:215], v15 offset:30720
    v_mfma_f32_16x16x32_bf16 v[152:155], a[72:75], a[244:247], v[152:155]
    buffer_load_dwordx4 a[32:35], v227, s[48:51], s31 offen offset:3072 sc1
    v_mfma_f32_16x16x32_bf16 v[156:159], a[244:247], a[76:79], v[156:159]
    v_cvt_pk_bf16_f32 v90, 0, v90
    v_cvt_pk_bf16_f32 v91, 0, v91
    v_mfma_f32_16x16x32_bf16 v[160:163], a[72:75], a[248:251], v[160:163]
    ds_read_b128 a[240:243], v15 offset:25600
    v_cvt_pk_bf16_f32 v96, 0, v96
    v_mfma_f32_16x16x32_bf16 v[164:167], a[248:251], a[76:79], v[164:167]
    v_cvt_pk_bf16_f32 v97, 0, v97
    s_waitcnt lgkmcnt(3)
    v_mfma_f32_16x16x32_bf16 v[168:171], a[72:75], a[252:255], v[168:171]
    ds_read_b128 a[244:247], v15 offset:27648
    v_mfma_f32_16x16x32_bf16 v[172:175], a[252:255], a[76:79], v[172:175]
    buffer_load_dwordx4 a[36:39], v228, s[48:51], s31 offen offset:3072 sc1
    v_mfma_f32_16x16x32_bf16 v[144:147], a[80:83], v[200:203], v[144:147]
    v_cvt_pk_bf16_f32 v98, 0, v98
    v_cvt_pk_bf16_f32 v99, 0, v99
    v_mfma_f32_16x16x32_bf16 v[148:151], v[200:203], a[84:87], v[148:151]
    ds_read_b128 a[248:251], v15 offset:29696
    v_max3_f32 v112, v88, v89, v90
    v_mfma_f32_16x16x32_bf16 v[152:155], a[80:83], v[204:207], v[152:155]
    v_max3_f32 v114, v96, v97, v98
    ds_read_b128 a[252:255], v15 offset:31744
    v_mfma_f32_16x16x32_bf16 v[156:159], v[204:207], a[84:87], v[156:159]
    s_add_u32 s31, s81, 4096
    buffer_load_dwordx4 a[40:43], v225, s[48:51], s31 offen offset:0 sc1
    v_max_f32 v112, v112, v91
    v_max_f32 v114, v114, v99
    s_waitcnt lgkmcnt(3)
    v_mfma_f32_16x16x32_bf16 v[160:163], a[80:83], v[208:211], v[160:163]
    ds_read_b128 v[200:203], v15 offset:40960
    v_mul_f32 v88, 0x3fb8aa3b, v88
    v_mfma_f32_16x16x32_bf16 v[164:167], v[208:211], a[84:87], v[164:167]
    v_mul_f32 v89, 0x3fb8aa3b, v89
    ds_read_b128 v[204:207], v15 offset:43008
    v_mfma_f32_16x16x32_bf16 v[168:171], a[80:83], v[212:215], v[168:171]
    buffer_load_dwordx4 a[44:47], v226, s[48:51], s31 offen offset:0 sc1
    v_mfma_f32_16x16x32_bf16 v[172:175], v[212:215], a[84:87], v[172:175]
    v_permlane32_swap_b32 v112, v114
    v_max_f32 v112, v112, v114
    v_mfma_f32_16x16x32_bf16 v[144:147], a[88:91], a[240:243], v[144:147]
    ds_read_b128 v[208:211], v15 offset:45056
    s_mov_b32 s83, 16384
    v_mfma_f32_16x16x32_bf16 v[148:151], a[240:243], a[92:95], v[148:151]
    s_add_u32 m0, s10, 135168
    s_nop 0
    buffer_load_dwordx4 v19, s[48:51], s83 offen sc1 lds
    v_mov_b32 v114, v112
    s_waitcnt lgkmcnt(3)
    v_mfma_f32_16x16x32_bf16 v[152:155], a[88:91], a[244:247], v[152:155]
    ds_read_b128 v[212:215], v15 offset:47104
    v_mfma_f32_16x16x32_bf16 v[156:159], a[244:247], a[92:95], v[156:159]
    buffer_load_dwordx4 a[48:51], v227, s[48:51], s31 offen offset:0 sc1
    v_mfma_f32_16x16x32_bf16 v[160:163], a[88:91], a[248:251], v[160:163]
    v_mul_f32 v90, 0x3fb8aa3b, v90
    v_mul_f32 v91, 0x3fb8aa3b, v91
    v_mfma_f32_16x16x32_bf16 v[164:167], a[248:251], a[92:95], v[164:167]
    ds_read_b128 a[240:243], v15 offset:41984
    v_permlane16_swap_b32 v112, v114
    v_mfma_f32_16x16x32_bf16 v[168:171], a[88:91], a[252:255], v[168:171]
    buffer_load_dwordx4 a[52:55], v228, s[48:51], s31 offen offset:0 sc1
    v_mfma_f32_16x16x32_bf16 v[172:175], a[252:255], a[92:95], v[172:175]
    ds_read_b128 a[244:247], v15 offset:44032
    v_max_f32 v112, v112, v114
    v_mov_b32 v114, v112
    v_mul_f32 v96, 0x3fb8aa3b, v96
    s_waitcnt lgkmcnt(3)
    v_mfma_f32_16x16x32_bf16 v[144:147], a[96:99], v[200:203], v[144:147]
    ds_read_b128 a[248:251], v15 offset:46080
    v_mul_f32 v97, 0x3fb8aa3b, v97
    v_mfma_f32_16x16x32_bf16 v[148:151], v[200:203], a[100:103], v[148:151]
    buffer_load_dwordx4 a[56:59], v225, s[48:51], s31 offen offset:1024 sc1
    v_mfma_f32_16x16x32_bf16 v[152:155], a[96:99], v[204:207], v[152:155]
    ds_read_b128 a[252:255], v15 offset:48128
    v_permlane32_swap_b32 v112, v114
    v_mfma_f32_16x16x32_bf16 v[156:159], v[204:207], a[100:103], v[156:159]
    v_mul_f32 v98, 0x3fb8aa3b, v98
    v_mul_f32 v99, 0x3fb8aa3b, v99
    v_mfma_f32_16x16x32_bf16 v[160:163], a[96:99], v[208:211], v[160:163]
    ds_read_b128 v[200:203], v15 offset:57344
    v_fmac_f32 v88, 0xbfb8aa3b, v112
    v_mfma_f32_16x16x32_bf16 v[164:167], v[208:211], a[100:103], v[164:167]
    buffer_load_dwordx4 a[60:63], v226, s[48:51], s31 offen offset:1024 sc1
    s_waitcnt lgkmcnt(3)
    v_mfma_f32_16x16x32_bf16 v[168:171], a[96:99], v[212:215], v[168:171]
    ds_read_b128 v[204:207], v15 offset:59392
    v_fmac_f32 v89, 0xbfb8aa3b, v112
    v_mfma_f32_16x16x32_bf16 v[172:175], v[212:215], a[100:103], v[172:175]
    v_fmac_f32 v90, 0xbfb8aa3b, v112
    v_fmac_f32 v91, 0xbfb8aa3b, v112
    v_mfma_f32_16x16x32_bf16 v[144:147], a[104:107], a[240:243], v[144:147]
    ds_read_b128 v[208:211], v15 offset:61440
    v_fmac_f32 v96, 0xbfb8aa3b, v114
    v_mfma_f32_16x16x32_bf16 v[148:151], a[240:243], a[108:111], v[148:151]
    buffer_load_dwordx4 a[64:67], v227, s[48:51], s31 offen offset:1024 sc1
    v_mfma_f32_16x16x32_bf16 v[152:155], a[104:107], a[244:247], v[152:155]
    s_mov_b32 s83, 20480
    s_add_u32 m0, s10, 151552
    v_mfma_f32_16x16x32_bf16 v[156:159], a[244:247], a[108:111], v[156:159]
    buffer_load_dwordx4 v19, s[48:51], s83 offen sc1 lds
    ds_read_b128 v[212:215], v15 offset:63488
    v_fmac_f32 v97, 0xbfb8aa3b, v114
    v_fmac_f32 v98, 0xbfb8aa3b, v114
    v_fmac_f32 v99, 0xbfb8aa3b, v114
    s_waitcnt lgkmcnt(3)
    v_mfma_f32_16x16x32_bf16 v[160:163], a[104:107], a[248:251], v[160:163]
    ds_read_b128 a[240:243], v15 offset:58368
    v_mfma_f32_16x16x32_bf16 v[164:167], a[248:251], a[108:111], v[164:167]
    buffer_load_dwordx4 a[68:71], v228, s[48:51], s31 offen offset:1024 sc1
    v_mfma_f32_16x16x32_bf16 v[168:171], a[104:107], a[252:255], v[168:171]
    v_exp_f32 v88, v88
    v_mfma_f32_16x16x32_bf16 v[172:175], a[252:255], a[108:111], v[172:175]
    ds_read_b128 a[244:247], v15 offset:60416
    v_mfma_f32_16x16x32_bf16 v[144:147], a[112:115], v[200:203], v[144:147]
    v_exp_f32 v89, v89
    v_mfma_f32_16x16x32_bf16 v[148:151], v[200:203], a[116:119], v[148:151]
    v_exp_f32 v90, v90
    v_exp_f32 v91, v91
    ds_read_b128 a[248:251], v15 offset:62464
    s_add_u32 s30, s80, 25600
    buffer_load_dwordx4 a[72:75], v1, s[48:51], s30 offen offset:0 sc1
    v_exp_f32 v96, v96
    s_waitcnt lgkmcnt(3)
    v_mfma_f32_16x16x32_bf16 v[152:155], a[112:115], v[204:207], v[152:155]
    ds_read_b128 a[252:255], v15 offset:64512
    v_mfma_f32_16x16x32_bf16 v[156:159], v[204:207], a[116:119], v[156:159]
    v_exp_f32 v97, v97
    v_mfma_f32_16x16x32_bf16 v[160:163], a[112:115], v[208:211], v[160:163]
    v_exp_f32 v98, v98
    v_mfma_f32_16x16x32_bf16 v[164:167], v[208:211], a[116:119], v[164:167]
    v_exp_f32 v99, v99
    v_mfma_f32_16x16x32_bf16 v[168:171], a[112:115], v[212:215], v[168:171]
    ds_read_b128 v[200:203], v16 offset:8192
    v_mfma_f32_16x16x32_bf16 v[172:175], v[212:215], a[116:119], v[172:175]
    buffer_load_dwordx4 a[76:79], v1, s[48:51], s30 offen offset:1024 sc1
    v_add_f32 v112, v88, v89
    ds_read_b128 v[204:207], v16 offset:10240
    v_add_f32 v113, v90, v91
    v_add_f32 v114, v96, v97
    v_add_f32 v115, v98, v99
    s_waitcnt lgkmcnt(3)
    v_mfma_f32_16x16x32_bf16 v[144:147], a[120:123], a[240:243], v[144:147]
    ds_read_b128 v[208:211], v16 offset:12288
    v_mfma_f32_16x16x32_bf16 v[148:151], a[240:243], a[124:127], v[148:151]
    buffer_load_dwordx4 a[80:83], v1, s[48:51], s30 offen offset:2048 sc1
    v_mfma_f32_16x16x32_bf16 v[152:155], a[120:123], a[244:247], v[152:155]
    v_add_f32 v112, v112, v113
    ds_read_b128 v[212:215], v16 offset:14336
    v_mfma_f32_16x16x32_bf16 v[156:159], a[244:247], a[124:127], v[156:159]
    v_add_f32 v114, v114, v115
    s_mov_b32 s83, 24576
    v_mfma_f32_16x16x32_bf16 v[160:163], a[120:123], a[248:251], v[160:163]
    s_add_u32 m0, s10, 81920
    v_mfma_f32_16x16x32_bf16 v[164:167], a[248:251], a[124:127], v[164:167]
    buffer_load_dwordx4 v19, s[48:51], s83 offen sc1 lds
    ds_read_b128 a[240:243], v16 offset:9216
    buffer_load_dwordx4 a[84:87], v1, s[48:51], s30 offen offset:3072 sc1
    s_waitcnt lgkmcnt(3)
    v_mfma_f32_16x16x32_bf16 v[168:171], a[120:123], a[252:255], v[168:171]
    ds_read_b128 a[244:247], v16 offset:11264
    v_permlane32_swap_b32 v112, v114
    v_mfma_f32_16x16x32_bf16 v[172:175], a[252:255], a[124:127], v[172:175]
    buffer_load_dwordx4 a[88:91], v224, s[48:51], s30 offen offset:0 sc1
    v_mfma_f32_16x16x32_bf16 v[144:147], a[128:131], v[200:203], v[144:147]
    v_add_f32 v112, v112, v114
    ds_read_b128 a[248:251], v16 offset:13312
    v_mfma_f32_16x16x32_bf16 v[148:151], v[200:203], a[132:135], v[148:151]
    v_mov_b32 v114, v112
    ds_read_b128 a[252:255], v16 offset:15360
    v_mfma_f32_16x16x32_bf16 v[152:155], a[128:131], v[204:207], v[152:155]
    buffer_load_dwordx4 a[92:95], v225, s[48:51], s31 offen offset:2048 sc1
    v_mfma_f32_16x16x32_bf16 v[156:159], v[204:207], a[132:135], v[156:159]
    v_permlane16_swap_b32 v112, v114
    s_waitcnt lgkmcnt(3)
    v_mfma_f32_16x16x32_bf16 v[160:163], a[128:131], v[208:211], v[160:163]
    ds_read_b128 v[200:203], v16 offset:24576
    v_add_f32 v112, v112, v114
    v_mfma_f32_16x16x32_bf16 v[164:167], v[208:211], a[132:135], v[164:167]
    v_rcp_f32 v112, v112
    v_mfma_f32_16x16x32_bf16 v[168:171], a[128:131], v[212:215], v[168:171]
    ds_read_b128 v[204:207], v16 offset:26624
    v_mfma_f32_16x16x32_bf16 v[172:175], v[212:215], a[132:135], v[172:175]
    buffer_load_dwordx4 a[96:99], v226, s[48:51], s31 offen offset:2048 sc1
    v_mfma_f32_16x16x32_bf16 v[144:147], a[136:139], a[240:243], v[144:147]
    v_mov_b32 v114, v112
    ds_read_b128 v[208:211], v16 offset:28672
    v_mfma_f32_16x16x32_bf16 v[148:151], a[240:243], a[140:143], v[148:151]
    s_waitcnt lgkmcnt(3)
    ds_read_b128 v[212:215], v16 offset:30720
    v_mfma_f32_16x16x32_bf16 v[152:155], a[136:139], a[244:247], v[152:155]
    v_permlane32_swap_b32 v112, v114
    v_mfma_f32_16x16x32_bf16 v[156:159], a[244:247], a[140:143], v[156:159]
    buffer_load_dwordx4 a[100:103], v227, s[48:51], s31 offen offset:2048 sc1
    v_mfma_f32_16x16x32_bf16 v[160:163], a[136:139], a[248:251], v[160:163]
    v_mul_f32 v88, v88, v112
    ds_read_b128 a[240:243], v16 offset:25600
    v_mfma_f32_16x16x32_bf16 v[164:167], a[248:251], a[140:143], v[164:167]
    s_mov_b32 s83, 28672
    s_add_u32 m0, s10, 98304
    v_mfma_f32_16x16x32_bf16 v[168:171], a[136:139], a[252:255], v[168:171]
    buffer_load_dwordx4 v19, s[48:51], s83 offen sc1 lds
    v_mfma_f32_16x16x32_bf16 v[172:175], a[252:255], a[140:143], v[172:175]
    v_mul_f32 v89, v89, v112
    ds_read_b128 a[244:247], v16 offset:27648
    buffer_load_dwordx4 a[104:107], v228, s[48:51], s31 offen offset:2048 sc1
    v_mul_f32 v90, v90, v112
    v_mul_f32 v91, v91, v112
    s_waitcnt lgkmcnt(3)
    v_mfma_f32_16x16x32_bf16 v[144:147], a[144:147], v[200:203], v[144:147]
    ds_read_b128 a[248:251], v16 offset:29696
    v_mul_f32 v96, v96, v114
    v_mfma_f32_16x16x32_bf16 v[148:151], v[200:203], a[148:151], v[148:151]
    v_mul_f32 v97, v97, v114
    ds_read_b128 a[252:255], v16 offset:31744
    v_mfma_f32_16x16x32_bf16 v[152:155], a[144:147], v[204:207], v[152:155]
    s_add_u32 s30, s80, 30720
    v_mfma_f32_16x16x32_bf16 v[156:159], v[204:207], a[148:151], v[156:159]
    buffer_load_dwordx4 a[108:111], v1, s[48:51], s30 offen offset:0 sc1
    v_mfma_f32_16x16x32_bf16 v[160:163], a[144:147], v[208:211], v[160:163]
    v_mul_f32 v98, v98, v114
    v_mul_f32 v99, v99, v114
    v_mfma_f32_16x16x32_bf16 v[164:167], v[208:211], a[148:151], v[164:167]
    v_cvt_pk_bf16_f32 v104, v88, v89
    v_cvt_pk_bf16_f32 v105, v90, v91
    v_cvt_pk_bf16_f32 v108, v96, v97
    s_waitcnt lgkmcnt(2)
    v_mfma_f32_16x16x32_bf16 v[168:171], a[144:147], v[212:215], v[168:171]
    buffer_load_dwordx4 a[112:115], v1, s[48:51], s30 offen offset:1024 sc1
    v_mfma_f32_16x16x32_bf16 v[172:175], v[212:215], a[148:151], v[172:175]
    v_cvt_pk_bf16_f32 v109, v98, v99
    v_and_b32 v106, v104, v248
    v_mfma_f32_16x16x32_bf16 v[144:147], a[152:155], a[240:243], v[144:147]
    v_and_b32 v107, v105, v249
    v_and_b32 v110, v108, v248
    v_mfma_f32_16x16x32_bf16 v[148:151], a[240:243], a[156:159], v[148:151]
    v_and_b32 v111, v109, v249
    v_mfma_f32_16x16x32_bf16 v[152:155], a[152:155], a[244:247], v[152:155]
    buffer_load_dwordx4 a[116:119], v1, s[48:51], s30 offen offset:2048 sc1
    v_mfma_f32_16x16x32_bf16 v[156:159], a[244:247], a[156:159], v[156:159]
    v_xor_b32 v104, v104, v106
    v_xor_b32 v105, v105, v107
    s_waitcnt lgkmcnt(0)
    v_mfma_f32_16x16x32_bf16 v[160:163], a[152:155], a[248:251], v[160:163]
    v_xor_b32 v108, v108, v110
    v_xor_b32 v109, v109, v111
    v_mfma_f32_16x16x32_bf16 v[164:167], a[248:251], a[156:159], v[164:167]
    v_mfma_f32_16x16x32_bf16 v[88:91], a[176:179], v[104:107], 0
    v_mfma_f32_16x16x32_bf16 v[168:171], a[152:155], a[252:255], v[168:171]
    v_mfma_f32_16x16x32_bf16 v[92:95], a[184:187], v[104:107], 0
    v_mfma_f32_16x16x32_bf16 v[172:175], a[252:255], a[156:159], v[172:175]
    v_mfma_f32_16x16x32_bf16 v[96:99], a[180:183], v[108:111], 0
    v_mfma_f32_16x16x32_bf16 v[100:103], a[184:187], v[108:111], 0
    s_waitcnt vmcnt(39)
    v_mfma_f32_16x16x32_bf16 v[60:63], v[176:179], a[216:219], 0
    buffer_load_dwordx4 v[204:207], v1, s[48:51], s30 offen offset:3072 sc1
    v_mfma_f32_16x16x32_bf16 a[120:123], v[176:179], a[220:223], 0
    v_cvt_pk_bf16_f32 v144, v144, v145
    v_cvt_pk_bf16_f32 v145, v146, v147
    v_mfma_f32_16x16x32_bf16 a[140:143], v[176:179], a[224:227], 0
    v_cvt_pk_bf16_f32 v116, v88, v89
    v_mfma_f32_16x16x32_bf16 a[240:243], v[176:179], a[228:231], 0
    buffer_load_dwordx4 v[208:211], v224, s[48:51], s30 offen offset:0 sc1
    v_mfma_f32_16x16x32_bf16 v[64:67], v[180:183], a[216:219], 0
    ds_write_b64 v29, v[144:145] offset:4096
    v_cvt_pk_bf16_f32 v148, v148, v149
    v_mfma_f32_16x16x32_bf16 a[124:127], v[180:183], a[220:223], 0
    v_cvt_pk_bf16_f32 v117, v90, v91
    v_cvt_pk_bf16_f32 v149, v150, v151
    v_mfma_f32_16x16x32_bf16 a[144:147], v[180:183], a[224:227], 0
    ds_write_b64 v29, v[148:149] offset:4608
    v_cvt_pk_bf16_f32 v118, v96, v97
    v_mfma_f32_16x16x32_bf16 a[244:247], v[180:183], a[228:231], 0
    v_cvt_pk_bf16_f32 v119, v98, v99
    v_cvt_pk_bf16_f32 v152, v152, v153
    v_mfma_f32_16x16x32_bf16 v[68:71], v[184:187], a[216:219], 0
    v_cvt_pk_bf16_f32 v153, v154, v155
    v_cvt_pk_bf16_f32 v112, v100, v101
    v_mfma_f32_16x16x32_bf16 a[128:131], v[184:187], a[220:223], 0
    v_cvt_pk_bf16_f32 v113, v102, v103
    v_mfma_f32_16x16x32_bf16 a[148:151], v[184:187], a[224:227], 0
    buffer_load_dwordx4 v[212:215], v225, s[48:51], s31 offen offset:3072 sc1
    v_mfma_f32_16x16x32_bf16 a[248:251], v[184:187], a[228:231], 0
    ds_write_b64 v29, v[152:153] offset:20480
    v_cvt_pk_bf16_f32 v156, v156, v157
    v_mfma_f32_16x16x32_bf16 v[72:75], v[188:191], a[216:219], 0
    v_cvt_pk_bf16_f32 v120, v92, v93
    v_cvt_pk_bf16_f32 v157, v158, v159
    v_mfma_f32_16x16x32_bf16 a[132:135], v[188:191], a[220:223], 0
    ds_write_b64 v29, v[156:157] offset:20992
    v_cvt_pk_bf16_f32 v121, v94, v95
    v_mfma_f32_16x16x32_bf16 a[152:155], v[188:191], a[224:227], 0
    v_permlane16_swap_b32 v112, v122
    v_cvt_pk_bf16_f32 v160, v160, v161
    v_mfma_f32_16x16x32_bf16 a[252:255], v[188:191], a[228:231], 0
    v_cvt_pk_bf16_f32 v161, v162, v163
    v_permlane16_swap_b32 v113, v123
    v_mfma_f32_16x16x32_bf16 v[76:79], v[192:195], a[216:219], 0
    buffer_store_dwordx4 v[116:119], v1, s[48:51], s78 offen sc0 sc1
    v_mfma_f32_16x16x32_bf16 a[136:139], v[192:195], a[220:223], 0
    buffer_load_dwordx4 v[176:179], v226, s[48:51], s31 offen offset:3072 sc1
    v_mfma_f32_16x16x32_bf16 a[156:159], v[192:195], a[224:227], 0
    ds_write_b64 v29, v[160:161] offset:36864
    v_cvt_pk_bf16_f32 v164, v164, v165
    v_mfma_f32_16x16x32_bf16 v[200:203], v[192:195], a[228:231], 0
    buffer_store_dwordx4 v[120:123], v252, s[48:51], s78 offen sc0 sc1
    v_cvt_pk_bf16_f32 v165, v166, v167
    ds_write_b64 v29, v[164:165] offset:37376
    v_cvt_pk_bf16_f32 v168, v168, v169
    v_cvt_pk_bf16_f32 v169, v170, v171
    buffer_load_dwordx4 v[180:183], v227, s[48:51], s31 offen offset:3072 sc1
    ds_write_b64 v29, v[168:169] offset:53248
    v_cvt_pk_bf16_f32 v172, v172, v173
    v_cvt_pk_bf16_f32 v173, v174, v175
    ds_write_b64 v29, v[172:173] offset:53760
    buffer_load_dwordx4 v[184:187], v228, s[48:51], s31 offen offset:3072 sc1
    s_add_u32 s30, s80, 35840
    buffer_load_dwordx4 v[188:191], v1, s[48:51], s30 offen offset:0 sc1
    s_waitcnt lgkmcnt(0)
    s_barrier
    ds_read_b64 v[80:81], v230 offset:0
    ds_read_b64_tr_b16 v[82:83], v234 offset:3584
    ds_read_b64 a[160:161], v230 offset:2048
    ds_read_b64_tr_b16 a[162:163], v234 offset:3648
    ds_read_b64 a[168:169], v232 offset:2048
    s_waitcnt vmcnt(43)
    v_mfma_f32_16x16x32_bf16 v[60:63], v[196:199], a[232:235], v[60:63]
    ds_read_b64_tr_b16 a[170:171], v251 offset:3648
    ds_read_b64 v[84:85], v230 offset:1024
    v_mfma_f32_16x16x32_bf16 a[120:123], v[196:199], a[236:239], a[120:123]
    ds_read_b64_tr_b16 v[86:87], v234 offset:3616
    v_mfma_f32_16x16x32_bf16 a[140:143], v[196:199], a[0:3], a[140:143]
    buffer_load_dwordx4 v[192:195], v1, s[48:51], s30 offen offset:1024 sc1
    v_mfma_f32_16x16x32_bf16 a[240:243], v[196:199], a[4:7], a[240:243]
    ds_read_b64 a[164:165], v230 offset:3072
    ds_read_b64_tr_b16 a[166:167], v234 offset:3680
    v_mfma_f32_16x16x32_bf16 v[64:67], v[32:35], a[232:235], v[64:67]
    ds_read_b64 a[172:173], v232 offset:3072
    ds_read_b64_tr_b16 a[174:175], v251 offset:3680
    s_waitcnt lgkmcnt(6)
    v_and_b32 v82, v82, v235
    v_and_b32 v83, v83, v235
    s_waitcnt lgkmcnt(0)
    v_and_b32 v86, v86, v235
    v_mfma_f32_16x16x32_bf16 v[88:91], a[160:163], v[80:83], v[236:239]
    v_and_b32 v87, v87, v235
    v_mfma_f32_16x16x32_bf16 a[124:127], v[32:35], a[236:239], a[124:127]
    buffer_load_dwordx4 v[196:199], v1, s[48:51], s30 offen offset:2048 sc1
    v_mfma_f32_16x16x32_bf16 v[92:95], a[168:171], v[80:83], v[240:243]
    ds_read_b64 a[186:187], v230 offset:2560
    v_mfma_f32_16x16x32_bf16 v[96:99], a[164:167], v[84:87], v[236:239]
    ds_read_b64 a[184:185], v232 offset:2560
    ds_read_b64 a[178:179], v230 offset:512
    v_mfma_f32_16x16x32_bf16 v[100:103], a[172:175], v[84:87], v[240:243]
    ds_read_b64 a[176:177], v232 offset:512
    v_mfma_f32_16x16x32_bf16 a[144:147], v[32:35], a[0:3], a[144:147]
    v_mfma_f32_16x16x32_bf16 a[244:247], v[32:35], a[4:7], a[244:247]
    buffer_load_dwordx4 v[32:35], v1, s[48:51], s30 offen offset:3072 sc1
    v_mfma_f32_16x16x32_bf16 v[68:71], v[36:39], a[232:235], v[68:71]
    ds_read_b64 a[182:183], v230 offset:1536
    ds_read_b64 a[180:181], v232 offset:1536
    v_mfma_f32_16x16x32_bf16 a[128:131], v[36:39], a[236:239], a[128:131]
    v_max_f32 v88, v88, v92
    v_max_f32 v89, v89, v93
    v_mfma_f32_16x16x32_bf16 a[148:151], v[36:39], a[0:3], a[148:151]
    v_max_f32 v90, v90, v94
    v_max_f32 v91, v91, v95
    v_mfma_f32_16x16x32_bf16 a[248:251], v[36:39], a[4:7], a[248:251]
    v_max_f32 v96, v96, v100
    v_max_f32 v97, v97, v101
    v_mfma_f32_16x16x32_bf16 v[72:75], v[40:43], a[232:235], v[72:75]
    buffer_load_dwordx4 a[216:219], v224, s[48:51], s30 offen offset:0 sc1
    v_mfma_f32_16x16x32_bf16 a[132:135], v[40:43], a[236:239], a[132:135]
    v_max_f32 v98, v98, v102
    v_max_f32 v99, v99, v103
    v_mfma_f32_16x16x32_bf16 a[152:155], v[40:43], a[0:3], a[152:155]
    v_cvt_pk_bf16_f32 v88, 0, v88
    v_cvt_pk_bf16_f32 v89, 0, v89
    v_mfma_f32_16x16x32_bf16 a[252:255], v[40:43], a[4:7], a[252:255]
    v_cvt_pk_bf16_f32 v90, 0, v90
    v_cvt_pk_bf16_f32 v91, 0, v91
    v_mfma_f32_16x16x32_bf16 v[76:79], v[44:47], a[232:235], v[76:79]
    v_cvt_pk_bf16_f32 v96, 0, v96
    v_cvt_pk_bf16_f32 v97, 0, v97
    v_mfma_f32_16x16x32_bf16 a[136:139], v[44:47], a[236:239], a[136:139]
    s_add_u32 s31, s81, 8192
    v_mfma_f32_16x16x32_bf16 a[156:159], v[44:47], a[0:3], a[156:159]
    buffer_load_dwordx4 v[36:39], v225, s[48:51], s31 offen offset:0 sc1
    v_mfma_f32_16x16x32_bf16 v[200:203], v[44:47], a[4:7], v[200:203]
    v_cvt_pk_bf16_f32 v98, 0, v98
    v_cvt_pk_bf16_f32 v99, 0, v99
    v_mul_f32 v88, 0x3e64f92e, v88
    v_mul_f32 v89, 0x3e64f92e, v89
    v_mul_f32 v90, 0x3e64f92e, v90
    v_mul_f32 v91, 0x3e64f92e, v91
    v_mul_f32 v96, 0x3e64f92e, v96
    v_mul_f32 v97, 0x3e64f92e, v97
    buffer_load_dwordx4 v[40:43], v226, s[48:51], s31 offen offset:0 sc1
    v_mul_f32 v98, 0x3e64f92e, v98
    v_mul_f32 v99, 0x3e64f92e, v99
    v_cvt_pk_bf16_f32 v88, 0, v88
    v_cvt_pk_bf16_f32 v89, 0, v89
    v_cvt_pk_bf16_f32 v90, 0, v90
    v_cvt_pk_bf16_f32 v91, 0, v91
    v_cvt_pk_bf16_f32 v96, 0, v96
    v_cvt_pk_bf16_f32 v97, 0, v97
    buffer_load_dwordx4 v[44:47], v227, s[48:51], s31 offen offset:0 sc1
    v_cvt_pk_bf16_f32 v98, 0, v98
    v_cvt_pk_bf16_f32 v99, 0, v99
    s_waitcnt vmcnt(45)
    v_mfma_f32_16x16x32_bf16 v[60:63], v[48:51], a[8:11], v[60:63]
    v_max3_f32 v112, v88, v89, v90
    v_max3_f32 v114, v96, v97, v98
    v_mfma_f32_16x16x32_bf16 a[120:123], v[48:51], a[12:15], a[120:123]
    v_max_f32 v112, v112, v91
    v_max_f32 v114, v114, v99
    v_mfma_f32_16x16x32_bf16 a[140:143], v[48:51], a[16:19], a[140:143]
    v_mul_f32 v88, 0x3fb8aa3b, v88
    v_mul_f32 v89, 0x3fb8aa3b, v89
    v_mfma_f32_16x16x32_bf16 a[240:243], v[48:51], a[20:23], a[240:243]
    buffer_load_dwordx4 a[220:223], v228, s[48:51], s31 offen offset:0 sc1
    v_mfma_f32_16x16x32_bf16 v[64:67], v[52:55], a[8:11], v[64:67]
    v_permlane32_swap_b32 v112, v114
    v_max_f32 v112, v112, v114
    v_mfma_f32_16x16x32_bf16 a[124:127], v[52:55], a[12:15], a[124:127]
    v_mov_b32 v114, v112
    v_mul_f32 v90, 0x3fb8aa3b, v90
    v_mfma_f32_16x16x32_bf16 a[144:147], v[52:55], a[16:19], a[144:147]
    v_mul_f32 v91, 0x3fb8aa3b, v91
    v_permlane16_swap_b32 v112, v114
    v_mfma_f32_16x16x32_bf16 a[244:247], v[52:55], a[20:23], a[244:247]
    v_max_f32 v112, v112, v114
    v_mov_b32 v114, v112
    v_mfma_f32_16x16x32_bf16 v[68:71], v[56:59], a[8:11], v[68:71]
    s_add_u32 s30, s80, 40960
    v_mfma_f32_16x16x32_bf16 a[128:131], v[56:59], a[12:15], a[128:131]
    buffer_load_dwordx4 v[48:51], v1, s[48:51], s30 offen offset:0 sc1
    v_mfma_f32_16x16x32_bf16 a[148:151], v[56:59], a[16:19], a[148:151]
    v_mul_f32 v96, 0x3fb8aa3b, v96
    v_mul_f32 v97, 0x3fb8aa3b, v97
    v_mfma_f32_16x16x32_bf16 a[248:251], v[56:59], a[20:23], a[248:251]
    v_permlane32_swap_b32 v112, v114
    v_mul_f32 v98, 0x3fb8aa3b, v98
    v_mfma_f32_16x16x32_bf16 v[72:75], v[128:131], a[8:11], v[72:75]
    v_mul_f32 v99, 0x3fb8aa3b, v99
    v_fmac_f32 v88, 0xbfb8aa3b, v112
    v_mfma_f32_16x16x32_bf16 a[132:135], v[128:131], a[12:15], a[132:135]
    v_fmac_f32 v89, 0xbfb8aa3b, v112
    v_fmac_f32 v90, 0xbfb8aa3b, v112
    v_mfma_f32_16x16x32_bf16 a[152:155], v[128:131], a[16:19], a[152:155]
    buffer_load_dwordx4 v[52:55], v1, s[48:51], s30 offen offset:1024 sc1
    v_mfma_f32_16x16x32_bf16 a[252:255], v[128:131], a[20:23], a[252:255]
    v_fmac_f32 v91, 0xbfb8aa3b, v112
    v_fmac_f32 v96, 0xbfb8aa3b, v114
    v_mfma_f32_16x16x32_bf16 v[76:79], v[132:135], a[8:11], v[76:79]
    v_fmac_f32 v97, 0xbfb8aa3b, v114
    v_fmac_f32 v98, 0xbfb8aa3b, v114
    v_mfma_f32_16x16x32_bf16 a[136:139], v[132:135], a[12:15], a[136:139]
    v_fmac_f32 v99, 0xbfb8aa3b, v114
    v_mfma_f32_16x16x32_bf16 a[156:159], v[132:135], a[16:19], a[156:159]
    v_exp_f32 v88, v88
    v_mfma_f32_16x16x32_bf16 v[200:203], v[132:135], a[20:23], v[200:203]
    v_exp_f32 v89, v89
    v_exp_f32 v90, v90
    buffer_load_dwordx4 v[56:59], v1, s[48:51], s30 offen offset:2048 sc1
    v_exp_f32 v91, v91
    v_exp_f32 v96, v96
    v_exp_f32 v97, v97
    v_exp_f32 v98, v98
    v_exp_f32 v99, v99
    v_add_f32 v112, v88, v89
    v_add_f32 v113, v90, v91
    v_add_f32 v114, v96, v97
    buffer_load_dwordx4 a[224:227], v1, s[48:51], s30 offen offset:3072 sc1
    v_add_f32 v115, v98, v99
    v_add_f32 v112, v112, v113
    v_add_f32 v114, v114, v115
    s_nop 1
    v_permlane32_swap_b32 v112, v114
    v_add_f32 v112, v112, v114
    v_mov_b32 v114, v112
    buffer_load_dwordx4 v[128:131], v224, s[48:51], s30 offen offset:0 sc1
    s_nop 0
    v_permlane16_swap_b32 v112, v114
    v_add_f32 v112, v112, v114
    v_rcp_f32 v112, v112
    s_nop 0
    v_mov_b32 v114, v112
    s_waitcnt vmcnt(46)
    v_mfma_f32_16x16x32_bf16 v[60:63], v[136:139], a[24:27], v[60:63]
    buffer_load_dwordx4 v[132:135], v225, s[48:51], s31 offen offset:1024 sc1
    v_mfma_f32_16x16x32_bf16 a[120:123], v[136:139], a[28:31], a[120:123]
    v_permlane32_swap_b32 v112, v114
    v_mul_f32 v88, v88, v112
    v_mfma_f32_16x16x32_bf16 a[140:143], v[136:139], a[32:35], a[140:143]
    v_mul_f32 v89, v89, v112
    v_mul_f32 v90, v90, v112
    v_mfma_f32_16x16x32_bf16 a[240:243], v[136:139], a[36:39], a[240:243]
    v_mul_f32 v91, v91, v112
    v_mul_f32 v96, v96, v114
    v_mfma_f32_16x16x32_bf16 v[64:67], v[140:143], a[24:27], v[64:67]
    v_mul_f32 v97, v97, v114
    v_mfma_f32_16x16x32_bf16 a[124:127], v[140:143], a[28:31], a[124:127]
    buffer_load_dwordx4 v[136:139], v226, s[48:51], s31 offen offset:1024 sc1
    v_mfma_f32_16x16x32_bf16 a[144:147], v[140:143], a[32:35], a[144:147]
    v_mul_f32 v98, v98, v114
    v_mul_f32 v99, v99, v114
    v_mfma_f32_16x16x32_bf16 a[244:247], v[140:143], a[36:39], a[244:247]
    v_cvt_pk_bf16_f32 v104, v88, v89
    v_cvt_pk_bf16_f32 v105, v90, v91
    v_mfma_f32_16x16x32_bf16 v[68:71], v[124:127], a[24:27], v[68:71]
    v_cvt_pk_bf16_f32 v108, v96, v97
    v_cvt_pk_bf16_f32 v109, v98, v99
    v_and_b32 v106, v104, v248
    v_and_b32 v107, v105, v249
    buffer_load_dwordx4 a[228:231], v227, s[48:51], s31 offen offset:1024 sc1
    v_and_b32 v110, v108, v248
    v_and_b32 v111, v109, v249
    v_xor_b32 v104, v104, v106
    v_xor_b32 v105, v105, v107
    v_xor_b32 v108, v108, v110
    v_xor_b32 v109, v109, v111
    s_waitcnt lgkmcnt(0)
    v_mfma_f32_16x16x32_bf16 v[88:91], a[176:179], v[104:107], 0
    buffer_load_dwordx4 v[140:143], v228, s[48:51], s31 offen offset:1024 sc1
    v_mfma_f32_16x16x32_bf16 v[92:95], a[184:187], v[104:107], 0
    v_mfma_f32_16x16x32_bf16 a[128:131], v[124:127], a[28:31], a[128:131]
    v_mfma_f32_16x16x32_bf16 v[96:99], a[180:183], v[108:111], 0
    v_mfma_f32_16x16x32_bf16 v[100:103], a[184:187], v[108:111], 0
    v_mfma_f32_16x16x32_bf16 a[148:151], v[124:127], a[32:35], a[148:151]
    s_add_u32 s30, s80, 46080
    v_mfma_f32_16x16x32_bf16 a[248:251], v[124:127], a[36:39], a[248:251]
    buffer_load_dwordx4 v[124:127], v1, s[48:51], s30 offen offset:0 sc1
    v_mfma_f32_16x16x32_bf16 v[72:75], a[188:191], a[24:27], v[72:75]
    v_cvt_pk_bf16_f32 v80, v88, v89
    v_cvt_pk_bf16_f32 v81, v90, v91
    v_mfma_f32_16x16x32_bf16 a[132:135], a[188:191], a[28:31], a[132:135]
    v_cvt_pk_bf16_f32 v82, v96, v97
    v_cvt_pk_bf16_f32 v83, v98, v99
    v_mfma_f32_16x16x32_bf16 a[152:155], a[188:191], a[32:35], a[152:155]
    v_cvt_pk_bf16_f32 v112, v100, v101
    v_cvt_pk_bf16_f32 v113, v102, v103
    v_mfma_f32_16x16x32_bf16 a[252:255], a[188:191], a[36:39], a[252:255]
    v_cvt_pk_bf16_f32 v84, v92, v93
    v_cvt_pk_bf16_f32 v85, v94, v95
    v_mfma_f32_16x16x32_bf16 v[76:79], a[192:195], a[24:27], v[76:79]
    buffer_load_dwordx4 a[232:235], v1, s[48:51], s30 offen offset:1024 sc1
    v_mfma_f32_16x16x32_bf16 a[136:139], a[192:195], a[28:31], a[136:139]
    v_permlane16_swap_b32 v112, v86
    v_permlane16_swap_b32 v113, v87
    v_mfma_f32_16x16x32_bf16 a[156:159], a[192:195], a[32:35], a[156:159]
    buffer_store_dwordx4 v[80:83], v1, s[48:51], s79 offen sc0 sc1
    v_mfma_f32_16x16x32_bf16 v[200:203], a[192:195], a[36:39], v[200:203]
    buffer_store_dwordx4 v[84:87], v252, s[48:51], s79 offen sc0 sc1
    buffer_load_dwordx4 a[236:239], v1, s[48:51], s30 offen offset:2048 sc1
    s_waitcnt vmcnt(50)
    v_mfma_f32_16x16x32_bf16 v[60:63], a[196:199], a[40:43], v[60:63]
    buffer_load_dwordx4 a[0:3], v1, s[48:51], s30 offen offset:3072 sc1
    v_mfma_f32_16x16x32_bf16 a[120:123], a[196:199], a[44:47], a[120:123]
    v_mfma_f32_16x16x32_bf16 a[140:143], a[196:199], a[48:51], a[140:143]
    buffer_load_dwordx4 a[4:7], v224, s[48:51], s30 offen offset:0 sc1
    v_mfma_f32_16x16x32_bf16 a[240:243], a[196:199], a[52:55], a[240:243]
    v_mfma_f32_16x16x32_bf16 v[64:67], a[200:203], a[40:43], v[64:67]
    v_mfma_f32_16x16x32_bf16 a[124:127], a[200:203], a[44:47], a[124:127]
    buffer_load_dwordx4 a[8:11], v225, s[48:51], s31 offen offset:2048 sc1
    v_mfma_f32_16x16x32_bf16 a[144:147], a[200:203], a[48:51], a[144:147]
    v_mfma_f32_16x16x32_bf16 a[244:247], a[200:203], a[52:55], a[244:247]
    v_mfma_f32_16x16x32_bf16 v[68:71], a[204:207], a[40:43], v[68:71]
    buffer_load_dwordx4 a[12:15], v226, s[48:51], s31 offen offset:2048 sc1
    v_mfma_f32_16x16x32_bf16 a[128:131], a[204:207], a[44:47], a[128:131]
    v_mfma_f32_16x16x32_bf16 a[148:151], a[204:207], a[48:51], a[148:151]
    v_mfma_f32_16x16x32_bf16 a[248:251], a[204:207], a[52:55], a[248:251]
    buffer_load_dwordx4 a[16:19], v227, s[48:51], s31 offen offset:2048 sc1
    v_mfma_f32_16x16x32_bf16 v[72:75], a[208:211], a[40:43], v[72:75]
    v_mfma_f32_16x16x32_bf16 a[132:135], a[208:211], a[44:47], a[132:135]
    v_mfma_f32_16x16x32_bf16 a[152:155], a[208:211], a[48:51], a[152:155]
    buffer_load_dwordx4 a[20:23], v228, s[48:51], s31 offen offset:2048 sc1
    v_mfma_f32_16x16x32_bf16 a[252:255], a[208:211], a[52:55], a[252:255]
    v_mfma_f32_16x16x32_bf16 v[76:79], a[212:215], a[40:43], v[76:79]
    v_mfma_f32_16x16x32_bf16 a[136:139], a[212:215], a[44:47], a[136:139]
    s_add_u32 s30, s80, 51200
    v_mfma_f32_16x16x32_bf16 a[156:159], a[212:215], a[48:51], a[156:159]
    buffer_load_dwordx4 a[188:191], v1, s[48:51], s30 offen offset:0 sc1
    v_mfma_f32_16x16x32_bf16 v[200:203], a[212:215], a[52:55], v[200:203]
    s_waitcnt vmcnt(46)
    v_mfma_f32_16x16x32_bf16 v[60:63], a[72:75], a[56:59], v[60:63]
    buffer_load_dwordx4 a[24:27], v1, s[48:51], s30 offen offset:1024 sc1
    v_mfma_f32_16x16x32_bf16 a[120:123], a[72:75], a[60:63], a[120:123]
    v_mfma_f32_16x16x32_bf16 a[140:143], a[72:75], a[64:67], a[140:143]
    v_mfma_f32_16x16x32_bf16 a[240:243], a[72:75], a[68:71], a[240:243]
    buffer_load_dwordx4 a[28:31], v1, s[48:51], s30 offen offset:2048 sc1
    v_mfma_f32_16x16x32_bf16 v[64:67], a[76:79], a[56:59], v[64:67]
    v_mfma_f32_16x16x32_bf16 a[124:127], a[76:79], a[60:63], a[124:127]
    v_mfma_f32_16x16x32_bf16 a[144:147], a[76:79], a[64:67], a[144:147]
    buffer_load_dwordx4 a[32:35], v1, s[48:51], s30 offen offset:3072 sc1
    v_mfma_f32_16x16x32_bf16 a[244:247], a[76:79], a[68:71], a[244:247]
    v_mfma_f32_16x16x32_bf16 v[68:71], a[80:83], a[56:59], v[68:71]
    v_mfma_f32_16x16x32_bf16 a[128:131], a[80:83], a[60:63], a[128:131]
    buffer_load_dwordx4 a[192:195], v224, s[48:51], s30 offen offset:0 sc1
    v_mfma_f32_16x16x32_bf16 a[148:151], a[80:83], a[64:67], a[148:151]
    v_mfma_f32_16x16x32_bf16 a[248:251], a[80:83], a[68:71], a[248:251]
    v_mfma_f32_16x16x32_bf16 v[72:75], a[84:87], a[56:59], v[72:75]
    buffer_load_dwordx4 a[36:39], v225, s[48:51], s31 offen offset:3072 sc1
    v_mfma_f32_16x16x32_bf16 a[132:135], a[84:87], a[60:63], a[132:135]
    v_mfma_f32_16x16x32_bf16 a[152:155], a[84:87], a[64:67], a[152:155]
    v_mfma_f32_16x16x32_bf16 a[252:255], a[84:87], a[68:71], a[252:255]
    buffer_load_dwordx4 a[196:199], v226, s[48:51], s31 offen offset:3072 sc1
    v_mfma_f32_16x16x32_bf16 v[76:79], a[88:91], a[56:59], v[76:79]
    v_mfma_f32_16x16x32_bf16 a[136:139], a[88:91], a[60:63], a[136:139]
    v_mfma_f32_16x16x32_bf16 a[156:159], a[88:91], a[64:67], a[156:159]
    v_mfma_f32_16x16x32_bf16 v[200:203], a[88:91], a[68:71], v[200:203]
    s_waitcnt vmcnt(42)
    v_mfma_f32_16x16x32_bf16 v[60:63], a[108:111], a[92:95], v[60:63]
    buffer_load_dwordx4 a[200:203], v227, s[48:51], s31 offen offset:3072 sc1
    v_mfma_f32_16x16x32_bf16 a[120:123], a[108:111], a[96:99], a[120:123]
    s_waitcnt vmcnt(15)
    s_barrier
    v_mfma_f32_16x16x32_bf16 a[140:143], a[108:111], a[100:103], a[140:143]
    s_mov_b64 exec, 1
    buffer_store_dword v30, v28, s[48:51], s85 offen offset:128 sc0 sc1
    s_mov_b64 exec, -1
    v_mfma_f32_16x16x32_bf16 a[240:243], a[108:111], a[104:107], a[240:243]
    buffer_load_dwordx4 a[204:207], v228, s[48:51], s31 offen offset:3072 sc1
    v_mfma_f32_16x16x32_bf16 v[64:67], a[112:115], a[92:95], v[64:67]
    s_add_u32 s30, s80, 56320
    v_mfma_f32_16x16x32_bf16 a[124:127], a[112:115], a[96:99], a[124:127]
    buffer_load_dwordx4 a[208:211], v1, s[48:51], s30 offen offset:0 sc1
    v_mfma_f32_16x16x32_bf16 a[144:147], a[112:115], a[100:103], a[144:147]
    v_mfma_f32_16x16x32_bf16 a[244:247], a[112:115], a[104:107], a[244:247]
    buffer_load_dwordx4 a[40:43], v1, s[48:51], s30 offen offset:1024 sc1
    v_mfma_f32_16x16x32_bf16 v[68:71], a[116:119], a[92:95], v[68:71]
    v_mfma_f32_16x16x32_bf16 a[128:131], a[116:119], a[96:99], a[128:131]
    v_mfma_f32_16x16x32_bf16 a[148:151], a[116:119], a[100:103], a[148:151]
    buffer_load_dwordx4 a[44:47], v1, s[48:51], s30 offen offset:2048 sc1
    v_mfma_f32_16x16x32_bf16 a[248:251], a[116:119], a[104:107], a[248:251]
    v_mfma_f32_16x16x32_bf16 v[72:75], v[204:207], a[92:95], v[72:75]
    v_mfma_f32_16x16x32_bf16 a[132:135], v[204:207], a[96:99], a[132:135]
    v_mfma_f32_16x16x32_bf16 a[152:155], v[204:207], a[100:103], a[152:155]
    v_mfma_f32_16x16x32_bf16 a[252:255], v[204:207], a[104:107], a[252:255]
    buffer_load_dwordx4 v[204:207], v1, s[48:51], s30 offen offset:3072 sc1
    v_mfma_f32_16x16x32_bf16 v[76:79], v[208:211], a[92:95], v[76:79]
    buffer_load_dwordx4 a[48:51], v224, s[48:51], s30 offen offset:0 sc1
    v_mfma_f32_16x16x32_bf16 a[136:139], v[208:211], a[96:99], a[136:139]
    v_mfma_f32_16x16x32_bf16 a[156:159], v[208:211], a[100:103], a[156:159]
    v_mfma_f32_16x16x32_bf16 v[200:203], v[208:211], a[104:107], v[200:203]
    s_mov_b32 s83, 32768
    s_add_u32 m0, s10, 114688
    v_mfma_f32_16x16x32_bf16 v[60:63], v[188:191], v[212:215], v[60:63]
    buffer_load_dwordx4 v19, s[48:51], s83 offen sc1 lds
    v_mfma_f32_16x16x32_bf16 a[120:123], v[188:191], v[176:179], a[120:123]
    v_mfma_f32_16x16x32_bf16 a[140:143], v[188:191], v[180:183], a[140:143]
    s_mov_b32 s83, 36864
    s_add_u32 m0, s10, 131072
    v_mfma_f32_16x16x32_bf16 a[240:243], v[188:191], v[184:187], a[240:243]
    buffer_load_dwordx4 v19, s[48:51], s83 offen sc1 lds
    v_mfma_f32_16x16x32_bf16 v[64:67], v[192:195], v[212:215], v[64:67]
    v_mfma_f32_16x16x32_bf16 a[124:127], v[192:195], v[176:179], a[124:127]
    s_mov_b32 s83, 40960
    s_add_u32 m0, s10, 147456
    v_mfma_f32_16x16x32_bf16 a[144:147], v[192:195], v[180:183], a[144:147]
    buffer_load_dwordx4 v19, s[48:51], s83 offen sc1 lds
    v_mfma_f32_16x16x32_bf16 a[244:247], v[192:195], v[184:187], a[244:247]
    v_mfma_f32_16x16x32_bf16 v[68:71], v[196:199], v[212:215], v[68:71]
    s_mov_b32 s83, 45056
    s_add_u32 m0, s10, 8192
    v_mfma_f32_16x16x32_bf16 a[128:131], v[196:199], v[176:179], a[128:131]
    buffer_load_dwordx4 v19, s[48:51], s83 offen sc1 lds
    v_mfma_f32_16x16x32_bf16 a[148:151], v[196:199], v[180:183], a[148:151]
    v_mfma_f32_16x16x32_bf16 a[248:251], v[196:199], v[184:187], a[248:251]
    s_mov_b32 s83, 49152
    s_add_u32 m0, s10, 12288
    v_mfma_f32_16x16x32_bf16 v[72:75], v[32:35], v[212:215], v[72:75]
    buffer_load_dwordx4 v19, s[48:51], s83 offen sc1 lds
    v_mfma_f32_16x16x32_bf16 a[132:135], v[32:35], v[176:179], a[132:135]
    v_mfma_f32_16x16x32_bf16 a[152:155], v[32:35], v[180:183], a[152:155]
    s_mov_b32 s83, 53248
    s_add_u32 m0, s10, 24576
    v_mfma_f32_16x16x32_bf16 a[252:255], v[32:35], v[184:187], a[252:255]
    buffer_load_dwordx4 v19, s[48:51], s83 offen sc1 lds
    v_mfma_f32_16x16x32_bf16 v[76:79], a[216:219], v[212:215], v[76:79]
    v_mfma_f32_16x16x32_bf16 a[136:139], a[216:219], v[176:179], a[136:139]
    s_mov_b32 s83, 57344
    s_add_u32 m0, s10, 28672
    v_mfma_f32_16x16x32_bf16 a[156:159], a[216:219], v[180:183], a[156:159]
    buffer_load_dwordx4 v19, s[48:51], s83 offen sc1 lds
    v_mfma_f32_16x16x32_bf16 v[200:203], a[216:219], v[184:187], v[200:203]
    v_mfma_f32_16x16x32_bf16 v[60:63], v[48:51], v[36:39], v[60:63]
    s_mov_b32 s83, 61440
    s_add_u32 m0, s10, 40960
    v_mfma_f32_16x16x32_bf16 a[120:123], v[48:51], v[40:43], a[120:123]
    buffer_load_dwordx4 v19, s[48:51], s83 offen sc1 lds
    v_mfma_f32_16x16x32_bf16 a[140:143], v[48:51], v[44:47], a[140:143]
    v_mfma_f32_16x16x32_bf16 a[240:243], v[48:51], a[220:223], a[240:243]
    v_mfma_f32_16x16x32_bf16 v[64:67], v[52:55], v[36:39], v[64:67]
    v_mfma_f32_16x16x32_bf16 a[124:127], v[52:55], v[40:43], a[124:127]
    v_mfma_f32_16x16x32_bf16 a[144:147], v[52:55], v[44:47], a[144:147]
    v_mfma_f32_16x16x32_bf16 a[244:247], v[52:55], a[220:223], a[244:247]
    v_mfma_f32_16x16x32_bf16 v[68:71], v[56:59], v[36:39], v[68:71]
    v_mfma_f32_16x16x32_bf16 a[128:131], v[56:59], v[40:43], a[128:131]
    buffer_load_dword v18, v221, s[48:51], 0 offen sc0 sc1
    v_mfma_f32_16x16x32_bf16 a[148:151], v[56:59], v[44:47], a[148:151]
    v_mfma_f32_16x16x32_bf16 a[248:251], v[56:59], a[220:223], a[248:251]
    v_mfma_f32_16x16x32_bf16 v[72:75], a[224:227], v[36:39], v[72:75]
    v_mfma_f32_16x16x32_bf16 a[132:135], a[224:227], v[40:43], a[132:135]
    v_mfma_f32_16x16x32_bf16 a[152:155], a[224:227], v[44:47], a[152:155]
    v_mfma_f32_16x16x32_bf16 a[252:255], a[224:227], a[220:223], a[252:255]
    v_mfma_f32_16x16x32_bf16 v[76:79], v[128:131], v[36:39], v[76:79]
    v_mfma_f32_16x16x32_bf16 a[136:139], v[128:131], v[40:43], a[136:139]
    v_mfma_f32_16x16x32_bf16 a[156:159], v[128:131], v[44:47], a[156:159]
    v_mfma_f32_16x16x32_bf16 v[200:203], v[128:131], a[220:223], v[200:203]
    s_waitcnt vmcnt(28)
    v_mfma_f32_16x16x32_bf16 a[120:123], v[124:127], v[136:139], a[120:123]
    s_waitcnt vmcnt(19)
    v_mfma_f32_16x16x32_bf16 a[120:123], a[188:191], a[12:15], a[120:123]
    s_waitcnt vmcnt(9)
    v_mfma_f32_16x16x32_bf16 a[120:123], a[208:211], a[196:199], a[120:123]
    v_mfma_f32_16x16x32_bf16 a[124:127], a[232:235], v[136:139], a[124:127]
    v_mfma_f32_16x16x32_bf16 a[124:127], a[24:27], a[12:15], a[124:127]
    v_mfma_f32_16x16x32_bf16 a[124:127], a[40:43], a[196:199], a[124:127]
    v_mfma_f32_16x16x32_bf16 a[128:131], a[236:239], v[136:139], a[128:131]
    v_mfma_f32_16x16x32_bf16 a[128:131], a[28:31], a[12:15], a[128:131]
    v_mfma_f32_16x16x32_bf16 a[128:131], a[44:47], a[196:199], a[128:131]
    v_mfma_f32_16x16x32_bf16 a[132:135], a[0:3], v[136:139], a[132:135]
    v_mfma_f32_16x16x32_bf16 a[132:135], a[32:35], a[12:15], a[132:135]
    ds_write_b128 v10, a[120:123] offset:0
    v_mfma_f32_16x16x32_bf16 a[132:135], v[204:207], a[196:199], a[132:135]
    v_mfma_f32_16x16x32_bf16 a[136:139], a[4:7], v[136:139], a[136:139]
    ds_write_b128 v10, a[124:127] offset:16384
    v_mfma_f32_16x16x32_bf16 a[136:139], a[192:195], a[12:15], a[136:139]
    v_mfma_f32_16x16x32_bf16 a[136:139], a[48:51], a[196:199], a[136:139]
    ds_write_b128 v10, a[128:131] offset:32768
    v_mfma_f32_16x16x32_bf16 a[140:143], v[124:127], a[228:231], a[140:143]
    v_mfma_f32_16x16x32_bf16 a[140:143], a[188:191], a[16:19], a[140:143]
    v_mfma_f32_16x16x32_bf16 a[140:143], a[208:211], a[200:203], a[140:143]
    ds_write_b128 v10, a[132:135] offset:49152
    v_mfma_f32_16x16x32_bf16 a[144:147], a[232:235], a[228:231], a[144:147]
    v_mfma_f32_16x16x32_bf16 a[144:147], a[24:27], a[16:19], a[144:147]
    v_mfma_f32_16x16x32_bf16 a[144:147], a[40:43], a[200:203], a[144:147]
    ds_write_b128 v11, a[136:139] offset:0
    v_mfma_f32_16x16x32_bf16 a[148:151], a[236:239], a[228:231], a[148:151]
    v_mfma_f32_16x16x32_bf16 a[148:151], a[28:31], a[16:19], a[148:151]
    v_mfma_f32_16x16x32_bf16 a[148:151], a[44:47], a[200:203], a[148:151]
    ds_write_b128 v12, a[140:143] offset:4096
    v_mfma_f32_16x16x32_bf16 a[152:155], a[0:3], a[228:231], a[152:155]
    v_mfma_f32_16x16x32_bf16 a[152:155], a[32:35], a[16:19], a[152:155]
    v_mfma_f32_16x16x32_bf16 a[152:155], v[204:207], a[200:203], a[152:155]
    ds_write_b128 v12, a[144:147] offset:20480
    v_mfma_f32_16x16x32_bf16 a[156:159], a[4:7], a[228:231], a[156:159]
    s_waitcnt vmcnt(0)
    v_cmp_ne_u32 vcc, s9, v18
    v_mfma_f32_16x16x32_bf16 a[156:159], a[192:195], a[16:19], a[156:159]
    v_mfma_f32_16x16x32_bf16 a[156:159], a[48:51], a[200:203], a[156:159]
    s_cbranch_vccnz L_plp12
L_pok11:
    s_add_u32 s31, s24, 0
    v_mfma_f32_16x16x32_bf16 a[240:243], v[124:127], v[140:143], a[240:243]
    buffer_load_dwordx4 a[212:215], v1, s[48:51], s31 offen offset:0 sc1
    v_mfma_f32_16x16x32_bf16 a[240:243], a[188:191], a[20:23], a[240:243]
    ds_write_b128 v12, a[148:151] offset:36864
    v_mfma_f32_16x16x32_bf16 a[240:243], a[208:211], a[204:207], a[240:243]
    buffer_load_dwordx4 a[52:55], v1, s[48:51], s31 offen offset:1024 sc1
    v_mfma_f32_16x16x32_bf16 a[244:247], a[232:235], v[140:143], a[244:247]
    ds_write_b128 v12, a[152:155] offset:53248
    v_mfma_f32_16x16x32_bf16 a[244:247], a[24:27], a[20:23], a[244:247]
    buffer_load_dwordx4 a[72:75], v1, s[48:51], s31 offen offset:2048 sc1
    v_mfma_f32_16x16x32_bf16 a[244:247], a[40:43], a[204:207], a[244:247]
    ds_write_b128 v13, a[156:159] offset:57344
    v_mfma_f32_16x16x32_bf16 a[248:251], a[236:239], v[140:143], a[248:251]
    buffer_load_dwordx4 a[76:79], v1, s[48:51], s31 offen offset:3072 sc1
    v_mfma_f32_16x16x32_bf16 a[248:251], a[28:31], a[20:23], a[248:251]
    ds_write_b128 v14, a[240:243] offset:61440
    v_mfma_f32_16x16x32_bf16 a[248:251], a[44:47], a[204:207], a[248:251]
    buffer_load_dwordx4 a[80:83], v224, s[48:51], s31 offen offset:0 sc1
    v_mfma_f32_16x16x32_bf16 a[252:255], a[0:3], v[140:143], a[252:255]
    ds_write_b128 v17, a[244:247] offset:8192
    v_mfma_f32_16x16x32_bf16 a[252:255], a[32:35], a[20:23], a[252:255]
    s_add_u32 s31, s24, 17408
    v_mfma_f32_16x16x32_bf16 a[252:255], v[204:207], a[204:207], a[252:255]
    buffer_load_dwordx4 a[84:87], v1, s[48:51], s31 offen offset:0 sc1
    v_mfma_f32_16x16x32_bf16 v[200:203], a[4:7], v[140:143], v[200:203]
    ds_write_b128 v17, a[248:251] offset:12288
    v_mfma_f32_16x16x32_bf16 v[200:203], a[192:195], a[20:23], v[200:203]
    buffer_load_dwordx4 a[56:59], v1, s[48:51], s31 offen offset:1024 sc1
    v_mfma_f32_16x16x32_bf16 v[200:203], a[48:51], a[204:207], v[200:203]
    v_mfma_f32_16x16x32_bf16 v[60:63], v[124:127], v[132:135], v[60:63]
    v_mfma_f32_16x16x32_bf16 v[60:63], a[188:191], a[8:11], v[60:63]
    ds_write_b128 v17, a[252:255] offset:24576
    v_mfma_f32_16x16x32_bf16 v[60:63], a[208:211], a[36:39], v[60:63]
    buffer_load_dwordx4 a[60:63], v1, s[48:51], s31 offen offset:2048 sc1
    v_mfma_f32_16x16x32_bf16 v[64:67], a[232:235], v[132:135], v[64:67]
    v_mfma_f32_16x16x32_bf16 v[64:67], a[24:27], a[8:11], v[64:67]
    v_mfma_f32_16x16x32_bf16 v[64:67], a[40:43], a[36:39], v[64:67]
    ds_write_b128 v17, v[200:203] offset:28672
    v_mfma_f32_16x16x32_bf16 v[68:71], a[236:239], v[132:135], v[68:71]
    buffer_load_dwordx4 a[64:67], v1, s[48:51], s31 offen offset:3072 sc1
    v_mfma_f32_16x16x32_bf16 v[68:71], a[28:31], a[8:11], v[68:71]
    buffer_load_dwordx4 a[88:91], v224, s[48:51], s31 offen offset:0 sc1
    v_mfma_f32_16x16x32_bf16 v[68:71], a[44:47], a[36:39], v[68:71]
    v_mfma_f32_16x16x32_bf16 v[72:75], a[0:3], v[132:135], v[72:75]
    v_mfma_f32_16x16x32_bf16 v[72:75], a[32:35], a[8:11], v[72:75]
    s_add_u32 s31, s24, 34816
    v_mfma_f32_16x16x32_bf16 v[72:75], v[204:207], a[36:39], v[72:75]
    buffer_load_dwordx4 a[68:71], v1, s[48:51], s31 offen offset:0 sc1
    v_mfma_f32_16x16x32_bf16 v[76:79], a[4:7], v[132:135], v[76:79]
    buffer_load_dwordx4 a[108:111], v1, s[48:51], s31 offen offset:1024 sc1
    v_mfma_f32_16x16x32_bf16 v[76:79], a[192:195], a[8:11], v[76:79]
    buffer_load_dwordx4 a[112:115], v1, s[48:51], s31 offen offset:2048 sc1
    v_mfma_f32_16x16x32_bf16 v[76:79], a[48:51], a[36:39], v[76:79]
    buffer_load_dwordx4 a[116:119], v1, s[48:51], s31 offen offset:3072 sc1
    buffer_load_dwordx4 a[92:95], v224, s[48:51], s31 offen offset:0 sc1
    s_waitcnt lgkmcnt(0)
    s_barrier
    ds_read_b128 v[100:103], v7 offset:0
    ds_read_b128 v[104:107], v7 offset:4096
    ds_read_b128 v[108:111], v8 offset:61440
    ds_read_b128 v[112:115], v7 offset:16384
    ds_read_b128 v[116:119], v7 offset:20480
    ds_read_b128 v[120:123], v9 offset:8192
    ds_read_b128 v[124:127], v7 offset:32768
    ds_read_b128 v[128:131], v7 offset:36864
    ds_read_b128 v[132:135], v9 offset:12288
    ds_read_b128 v[136:139], v7 offset:49152
    ds_read_b128 v[140:143], v7 offset:53248
    ds_read_b128 v[144:147], v9 offset:24576
    ds_read_b128 v[148:151], v8 offset:0
    ds_read_b128 v[152:155], v8 offset:57344
    ds_read_b128 v[156:159], v9 offset:28672
    s_mov_b32 s12, 0xbfb8aa3b
    s_mov_b32 s13, 0xbfb8aa3b
    s_waitcnt lgkmcnt(12)
    v_pk_add_f32 v[100:101], v[100:101], v[104:105]
    v_pk_add_f32 v[108:109], v[108:109], v[60:61]
    v_pk_add_f32 v[102:103], v[102:103], v[106:107]
    v_pk_add_f32 v[110:111], v[110:111], v[62:63]
    v_pk_add_f32 v[100:101], v[100:101], v[108:109]
    v_pk_add_f32 v[102:103], v[102:103], v[110:111]
    v_cvt_pk_bf16_f32 v100, 0, v100
    v_cvt_pk_bf16_f32 v101, 0, v101
    v_cvt_pk_bf16_f32 v102, 0, v102
    v_cvt_pk_bf16_f32 v103, 0, v103
    v_pk_mul_f32 v[104:105], v[100:101], s[12:13]
    v_pk_mul_f32 v[106:107], v[102:103], s[12:13]
    s_add_u32 s31, s24, 52224
    buffer_load_dwordx4 a[96:99], v1, s[48:51], s31 offen offset:0 sc1
    buffer_load_dwordx4 a[100:103], v1, s[48:51], s31 offen offset:1024 sc1
    s_waitcnt lgkmcnt(9)
    v_pk_add_f32 v[112:113], v[112:113], v[116:117]
    v_pk_add_f32 v[120:121], v[120:121], v[64:65]
    v_pk_add_f32 v[114:115], v[114:115], v[118:119]
    v_pk_add_f32 v[122:123], v[122:123], v[66:67]
    v_pk_add_f32 v[112:113], v[112:113], v[120:121]
    v_pk_add_f32 v[114:115], v[114:115], v[122:123]
    v_cvt_pk_bf16_f32 v112, 0, v112
    v_cvt_pk_bf16_f32 v113, 0, v113
    v_cvt_pk_bf16_f32 v114, 0, v114
    v_cvt_pk_bf16_f32 v115, 0, v115
    v_pk_mul_f32 v[116:117], v[112:113], s[12:13]
    v_pk_mul_f32 v[118:119], v[114:115], s[12:13]
    buffer_load_dwordx4 a[104:107], v1, s[48:51], s31 offen offset:2048 sc1
    buffer_load_dwordx4 a[216:219], v1, s[48:51], s31 offen offset:3072 sc1
    s_waitcnt lgkmcnt(6)
    v_pk_add_f32 v[124:125], v[124:125], v[128:129]
    v_pk_add_f32 v[132:133], v[132:133], v[68:69]
    v_pk_add_f32 v[126:127], v[126:127], v[130:131]
    v_pk_add_f32 v[134:135], v[134:135], v[70:71]
    v_pk_add_f32 v[124:125], v[124:125], v[132:133]
    v_pk_add_f32 v[126:127], v[126:127], v[134:135]
    v_cvt_pk_bf16_f32 v124, 0, v124
    v_cvt_pk_bf16_f32 v125, 0, v125
    v_cvt_pk_bf16_f32 v126, 0, v126
    v_cvt_pk_bf16_f32 v127, 0, v127
    v_pk_mul_f32 v[128:129], v[124:125], s[12:13]
    v_pk_mul_f32 v[130:131], v[126:127], s[12:13]
    buffer_load_dwordx4 a[224:227], v224, s[48:51], s31 offen offset:0 sc1
    s_waitcnt lgkmcnt(3)
    v_pk_add_f32 v[136:137], v[136:137], v[140:141]
    v_pk_add_f32 v[144:145], v[144:145], v[72:73]
    v_pk_add_f32 v[138:139], v[138:139], v[142:143]
    v_pk_add_f32 v[146:147], v[146:147], v[74:75]
    v_pk_add_f32 v[136:137], v[136:137], v[144:145]
    v_pk_add_f32 v[138:139], v[138:139], v[146:147]
    v_cvt_pk_bf16_f32 v136, 0, v136
    v_cvt_pk_bf16_f32 v137, 0, v137
    v_cvt_pk_bf16_f32 v138, 0, v138
    v_cvt_pk_bf16_f32 v139, 0, v139
    v_pk_mul_f32 v[140:141], v[136:137], s[12:13]
    v_pk_mul_f32 v[142:143], v[138:139], s[12:13]
    s_waitcnt lgkmcnt(0)
    v_pk_add_f32 v[148:149], v[148:149], v[152:153]
    v_pk_add_f32 v[156:157], v[156:157], v[76:77]
    v_pk_add_f32 v[150:151], v[150:151], v[154:155]
    v_pk_add_f32 v[158:159], v[158:159], v[78:79]
    v_pk_add_f32 v[148:149], v[148:149], v[156:157]
    v_pk_add_f32 v[150:151], v[150:151], v[158:159]
    v_cvt_pk_bf16_f32 v148, 0, v148
    v_cvt_pk_bf16_f32 v149, 0, v149
    v_cvt_pk_bf16_f32 v150, 0, v150
    v_cvt_pk_bf16_f32 v151, 0, v151
    v_pk_mul_f32 v[152:153], v[148:149], s[12:13]
    v_pk_mul_f32 v[154:155], v[150:151], s[12:13]
    buffer_load_dwordx4 v[236:239], v2, s[36:39], s76 offen
    buffer_load_dwordx4 v[240:243], v3, s[36:39], s76 offen
    buffer_load_dwordx4 v[244:247], v4, s[36:39], s76 offen
    ds_read_b128 v[180:183], v15 offset:4096
    ds_read_b128 v[184:187], v15 offset:5120
    ds_read_b128 v[188:191], v15 offset:6144
    ds_read_b128 v[192:195], v15 offset:7168
    ds_read_b128 v[196:199], v15 offset:20480
    ds_read_b128 v[200:203], v15 offset:21504
    v_exp_f32 v104, v104
    s_mov_b32 s83, 65536
    s_add_u32 m0, s10, 45056
    s_nop 0
    buffer_load_dwordx4 v19, s[48:51], s83 offen sc1 lds
    v_exp_f32 v105, v105
    v_exp_f32 v106, v106
    v_exp_f32 v107, v107
    v_add_f32 v104, 1.0, v104
    v_add_f32 v105, 1.0, v105
    v_add_f32 v106, 1.0, v106
    v_add_f32 v107, 1.0, v107
    v_rcp_f32 v104, v104
    s_mov_b32 s83, 69632
    s_add_u32 m0, s10, 57344
    s_nop 0
    buffer_load_dwordx4 v19, s[48:51], s83 offen sc1 lds
    v_rcp_f32 v105, v105
    v_rcp_f32 v106, v106
    v_rcp_f32 v107, v107
    v_mul_f32 v100, v100, v104
    v_mul_f32 v101, v101, v105
    v_mul_f32 v102, v102, v106
    v_mul_f32 v103, v103, v107
    v_cvt_pk_bf16_f32 v100, 0, v100
    s_mov_b32 s83, 73728
    s_add_u32 m0, s10, 61440
    s_nop 0
    buffer_load_dwordx4 v19, s[48:51], s83 offen sc1 lds
    v_cvt_pk_bf16_f32 v101, 0, v101
    v_cvt_pk_bf16_f32 v102, 0, v102
    v_cvt_pk_bf16_f32 v103, 0, v103
    v_exp_f32 v116, v116
    v_exp_f32 v117, v117
    v_exp_f32 v118, v118
    v_exp_f32 v119, v119
    v_add_f32 v116, 1.0, v116
    s_mov_b32 s83, 77824
    s_add_u32 m0, s10, 73728
    s_nop 0
    buffer_load_dwordx4 v19, s[48:51], s83 offen sc1 lds
    v_add_f32 v117, 1.0, v117
    v_add_f32 v118, 1.0, v118
    v_add_f32 v119, 1.0, v119
    v_rcp_f32 v116, v116
    v_rcp_f32 v117, v117
    v_rcp_f32 v118, v118
    v_rcp_f32 v119, v119
    v_mul_f32 v112, v112, v116
    s_mov_b32 s83, 81920
    s_add_u32 m0, s10, 77824
    s_nop 0
    buffer_load_dwordx4 v19, s[48:51], s83 offen sc1 lds
    v_mul_f32 v113, v113, v117
    v_mul_f32 v114, v114, v118
    v_mul_f32 v115, v115, v119
    v_cvt_pk_bf16_f32 v112, 0, v112
    v_cvt_pk_bf16_f32 v113, 0, v113
    v_cvt_pk_bf16_f32 v114, 0, v114
    v_cvt_pk_bf16_f32 v115, 0, v115
    v_exp_f32 v128, v128
    s_mov_b32 s83, 86016
    s_add_u32 m0, s10, 90112
    s_nop 0
    buffer_load_dwordx4 v19, s[48:51], s83 offen sc1 lds
    v_exp_f32 v129, v129
    v_exp_f32 v130, v130
    v_exp_f32 v131, v131
    v_add_f32 v128, 1.0, v128
    v_add_f32 v129, 1.0, v129
    v_add_f32 v130, 1.0, v130
    v_add_f32 v131, 1.0, v131
    v_rcp_f32 v128, v128
    s_mov_b32 s83, 90112
    s_add_u32 m0, s10, 94208
    s_nop 0
    buffer_load_dwordx4 v19, s[48:51], s83 offen sc1 lds
    v_rcp_f32 v129, v129
    v_rcp_f32 v130, v130
    v_rcp_f32 v131, v131
    v_mul_f32 v124, v124, v128
    v_mul_f32 v125, v125, v129
    v_mul_f32 v126, v126, v130
    v_mul_f32 v127, v127, v131
    v_cvt_pk_bf16_f32 v124, 0, v124
    s_mov_b32 s83, 94208
    s_add_u32 m0, s10, 106496
    s_nop 0
    buffer_load_dwordx4 v19, s[48:51], s83 offen sc1 lds
    v_cvt_pk_bf16_f32 v125, 0, v125
    v_cvt_pk_bf16_f32 v126, 0, v126
    v_cvt_pk_bf16_f32 v127, 0, v127
    v_exp_f32 v140, v140
    v_exp_f32 v141, v141
    v_exp_f32 v142, v142
    v_exp_f32 v143, v143
    v_add_f32 v140, 1.0, v140
    s_mov_b32 s83, 98304
    s_add_u32 m0, s10, 110592
    s_nop 0
    buffer_load_dwordx4 v19, s[48:51], s83 offen sc1 lds
    v_add_f32 v141, 1.0, v141
    v_add_f32 v142, 1.0, v142
    v_add_f32 v143, 1.0, v143
    v_rcp_f32 v140, v140
    v_rcp_f32 v141, v141
    s_waitcnt vmcnt(31) lgkmcnt(3)
    v_mfma_f32_16x16x32_bf16 v[32:35], v[180:183], a[212:215], 0
    ds_read_b128 v[204:207], v15 offset:22528
    v_mfma_f32_16x16x32_bf16 v[36:39], v[184:187], a[212:215], 0
    v_rcp_f32 v142, v142
    v_mfma_f32_16x16x32_bf16 v[40:43], v[188:191], a[212:215], 0
    ds_read_b128 v[208:211], v15 offset:23552
    v_rcp_f32 v143, v143
    ds_read_b128 v[180:183], v15 offset:36864
    v_mul_f32 v136, v136, v140
    s_waitcnt lgkmcnt(3)
    v_mfma_f32_16x16x32_bf16 v[44:47], v[192:195], a[212:215], 0
    ds_read_b128 v[184:187], v15 offset:37888
    v_mul_f32 v137, v137, v141
    v_mfma_f32_16x16x32_bf16 v[48:51], v[196:199], a[212:215], 0
    ds_read_b128 v[188:191], v15 offset:38912
    v_mul_f32 v138, v138, v142
    s_waitcnt vmcnt(30)
    v_mfma_f32_16x16x32_bf16 v[32:35], v[200:203], a[52:55], v[32:35]
    ds_read_b128 v[192:195], v15 offset:39936
    v_mul_f32 v139, v139, v143
    s_waitcnt lgkmcnt(3)
    v_mfma_f32_16x16x32_bf16 v[36:39], v[204:207], a[52:55], v[36:39]
    ds_read_b128 v[196:199], v15 offset:53248
    v_cvt_pk_bf16_f32 v136, 0, v136
    v_mfma_f32_16x16x32_bf16 v[40:43], v[208:211], a[52:55], v[40:43]
    ds_read_b128 v[200:203], v15 offset:54272
    v_cvt_pk_bf16_f32 v137, 0, v137
    v_mfma_f32_16x16x32_bf16 v[44:47], v[180:183], a[52:55], v[44:47]
    ds_read_b128 v[204:207], v15 offset:55296
    v_cvt_pk_bf16_f32 v138, 0, v138
    s_waitcnt lgkmcnt(3)
    v_mfma_f32_16x16x32_bf16 v[48:51], v[184:187], a[52:55], v[48:51]
    ds_read_b128 v[208:211], v15 offset:56320
    v_cvt_pk_bf16_f32 v139, 0, v139
    s_waitcnt vmcnt(29)
    v_mfma_f32_16x16x32_bf16 v[32:35], v[188:191], a[72:75], v[32:35]
    ds_read_b128 v[180:183], v16 offset:4096
    v_mfma_f32_16x16x32_bf16 v[36:39], v[192:195], a[72:75], v[36:39]
    v_exp_f32 v152, v152
    ds_read_b128 v[184:187], v16 offset:5120
    v_exp_f32 v153, v153
    s_waitcnt lgkmcnt(3)
    v_mfma_f32_16x16x32_bf16 v[40:43], v[196:199], a[72:75], v[40:43]
    ds_read_b128 v[188:191], v16 offset:6144
    v_mfma_f32_16x16x32_bf16 v[44:47], v[200:203], a[72:75], v[44:47]
    v_exp_f32 v154, v154
    v_mfma_f32_16x16x32_bf16 v[48:51], v[204:207], a[72:75], v[48:51]
    ds_read_b128 v[192:195], v16 offset:7168
    v_exp_f32 v155, v155
    ds_read_b128 v[196:199], v16 offset:20480
    v_add_f32 v152, 1.0, v152
    s_waitcnt vmcnt(28) lgkmcnt(3)
    v_mfma_f32_16x16x32_bf16 v[32:35], v[208:211], a[76:79], v[32:35]
    ds_read_b128 v[200:203], v16 offset:21504
    v_add_f32 v153, 1.0, v153
    v_mfma_f32_16x16x32_bf16 v[36:39], v[180:183], a[76:79], v[36:39]
    ds_read_b128 v[204:207], v16 offset:22528
    v_add_f32 v154, 1.0, v154
    v_mfma_f32_16x16x32_bf16 v[40:43], v[184:187], a[76:79], v[40:43]
    ds_read_b128 v[208:211], v16 offset:23552
    v_add_f32 v155, 1.0, v155
    s_waitcnt lgkmcnt(3)
    v_mfma_f32_16x16x32_bf16 v[44:47], v[188:191], a[76:79], v[44:47]
    ds_read_b128 v[180:183], v15 offset:16384
    v_mfma_f32_16x16x32_bf16 v[48:51], v[192:195], a[76:79], v[48:51]
    v_rcp_f32 v152, v152
    ds_read_b128 v[184:187], v15 offset:17408
    v_rcp_f32 v153, v153
    s_waitcnt vmcnt(27)
    v_mfma_f32_16x16x32_bf16 v[32:35], v[196:199], a[80:83], v[32:35]
    ds_read_b128 v[188:191], v15 offset:18432
    v_rcp_f32 v154, v154
    s_waitcnt lgkmcnt(3)
    v_mfma_f32_16x16x32_bf16 v[36:39], v[200:203], a[80:83], v[36:39]
    ds_read_b128 v[192:195], v15 offset:19456
    v_mfma_f32_16x16x32_bf16 v[40:43], v[204:207], a[80:83], v[40:43]
    v_rcp_f32 v155, v155
    v_mfma_f32_16x16x32_bf16 v[44:47], v[208:211], a[80:83], v[44:47]
    ds_read_b128 v[196:199], v15 offset:32768
    v_mul_f32 v148, v148, v152
    ds_read_b128 v[200:203], v15 offset:33792
    v_mul_f32 v149, v149, v153
    s_waitcnt lgkmcnt(3)
    v_mfma_f32_16x16x32_bf16 v[48:51], v[180:183], a[80:83], v[48:51]
    ds_read_b128 v[204:207], v15 offset:34816
    v_mul_f32 v150, v150, v154
    s_waitcnt vmcnt(26)
    v_mfma_f32_16x16x32_bf16 v[32:35], v[184:187], a[84:87], v[32:35]
    ds_read_b128 v[208:211], v15 offset:35840
    v_mul_f32 v151, v151, v155
    v_mfma_f32_16x16x32_bf16 v[36:39], v[188:191], a[84:87], v[36:39]
    ds_read_b128 v[180:183], v15 offset:49152
    v_cvt_pk_bf16_f32 v148, 0, v148
    s_waitcnt lgkmcnt(3)
    v_mfma_f32_16x16x32_bf16 v[40:43], v[192:195], a[84:87], v[40:43]
    ds_read_b128 v[184:187], v15 offset:50176
    v_cvt_pk_bf16_f32 v149, 0, v149
    v_mfma_f32_16x16x32_bf16 v[44:47], v[196:199], a[84:87], v[44:47]
    ds_read_b128 v[188:191], v15 offset:51200
    v_cvt_pk_bf16_f32 v150, 0, v150
    v_mfma_f32_16x16x32_bf16 v[48:51], v[200:203], a[84:87], v[48:51]
    ds_read_b128 v[192:195], v15 offset:52224
    v_cvt_pk_bf16_f32 v151, 0, v151
    s_waitcnt vmcnt(25) lgkmcnt(3)
    v_mfma_f32_16x16x32_bf16 v[32:35], v[204:207], a[56:59], v[32:35]
    ds_read_b128 v[196:199], v16 offset:0
    s_waitcnt vmcnt(9)
    v_mfma_f32_16x16x32_bf16 v[36:39], v[208:211], a[56:59], v[36:39]
    ds_read_b128 v[200:203], v16 offset:1024
    v_lshlrev_b32 v52, 16, v236
    v_mfma_f32_16x16x32_bf16 v[40:43], v[180:183], a[56:59], v[40:43]
    ds_read_b128 v[204:207], v16 offset:2048
    v_and_b32 v53, 0xffff0000, v236
    s_waitcnt lgkmcnt(3)
    v_mfma_f32_16x16x32_bf16 v[44:47], v[184:187], a[56:59], v[44:47]
    ds_read_b128 v[208:211], v16 offset:3072
    v_lshlrev_b32 v54, 16, v237
    v_mfma_f32_16x16x32_bf16 v[48:51], v[188:191], a[56:59], v[48:51]
    ds_read_b128 v[180:183], v16 offset:16384
    v_and_b32 v55, 0xffff0000, v237
    v_mfma_f32_16x16x32_bf16 v[32:35], v[192:195], a[60:63], v[32:35]
    ds_read_b128 v[184:187], v16 offset:17408
    v_lshlrev_b32 v56, 16, v238
    s_waitcnt lgkmcnt(3)
    v_mfma_f32_16x16x32_bf16 v[36:39], v[196:199], a[60:63], v[36:39]
    ds_read_b128 v[188:191], v16 offset:18432
    v_and_b32 v57, 0xffff0000, v238
    v_mfma_f32_16x16x32_bf16 v[40:43], v[200:203], a[60:63], v[40:43]
    ds_read_b128 v[192:195], v16 offset:19456
    v_lshlrev_b32 v58, 16, v239
    v_mfma_f32_16x16x32_bf16 v[44:47], v[204:207], a[60:63], v[44:47]
    ds_read_b128 v[196:199], v1 offset:8192
    v_and_b32 v59, 0xffff0000, v239
    s_waitcnt lgkmcnt(3)
    v_mfma_f32_16x16x32_bf16 v[48:51], v[208:211], a[60:63], v[48:51]
    ds_read_b128 v[200:203], v1 offset:9216
    v_lshlrev_b32 v68, 16, v240
    v_mfma_f32_16x16x32_bf16 v[32:35], v[180:183], a[64:67], v[32:35]
    ds_read_b128 v[204:207], v1 offset:10240
    v_and_b32 v69, 0xffff0000, v240
    v_mfma_f32_16x16x32_bf16 v[36:39], v[184:187], a[64:67], v[36:39]
    ds_read_b128 v[208:211], v1 offset:11264
    v_lshlrev_b32 v70, 16, v241
    s_waitcnt lgkmcnt(3)
    v_mfma_f32_16x16x32_bf16 v[40:43], v[188:191], a[64:67], v[40:43]
    ds_read_b128 v[180:183], v1 offset:12288
    v_and_b32 v71, 0xffff0000, v241
    v_mfma_f32_16x16x32_bf16 v[44:47], v[192:195], a[64:67], v[44:47]
    ds_read_b128 v[184:187], v1 offset:13312
    v_lshlrev_b32 v72, 16, v242
    v_mfma_f32_16x16x32_bf16 v[48:51], v[196:199], a[64:67], v[48:51]
    ds_read_b128 v[188:191], v1 offset:14336
    v_and_b32 v73, 0xffff0000, v242
    s_waitcnt lgkmcnt(3)
    v_mfma_f32_16x16x32_bf16 v[32:35], v[200:203], a[88:91], v[32:35]
    ds_read_b128 v[192:195], v1 offset:15360
    v_lshlrev_b32 v74, 16, v243
    v_mfma_f32_16x16x32_bf16 v[36:39], v[204:207], a[88:91], v[36:39]
    ds_read_b128 v[196:199], v1 offset:24576
    v_and_b32 v75, 0xffff0000, v243
    v_mfma_f32_16x16x32_bf16 v[40:43], v[208:211], a[88:91], v[40:43]
    ds_read_b128 v[200:203], v1 offset:25600
    v_lshlrev_b32 v84, 16, v244
    s_waitcnt lgkmcnt(3)
    v_mfma_f32_16x16x32_bf16 v[44:47], v[180:183], a[88:91], v[44:47]
    ds_read_b128 v[204:207], v1 offset:26624
    v_and_b32 v85, 0xffff0000, v244
    v_mfma_f32_16x16x32_bf16 v[48:51], v[184:187], a[88:91], v[48:51]
    ds_read_b128 v[208:211], v1 offset:27648
    v_lshlrev_b32 v86, 16, v245
    v_mfma_f32_16x16x32_bf16 v[32:35], v[188:191], a[68:71], v[32:35]
    ds_read_b128 v[180:183], v1 offset:28672
    v_and_b32 v87, 0xffff0000, v245
    s_waitcnt lgkmcnt(3)
    v_mfma_f32_16x16x32_bf16 v[36:39], v[192:195], a[68:71], v[36:39]
    ds_read_b128 v[184:187], v1 offset:29696
    v_lshlrev_b32 v88, 16, v246
    v_mfma_f32_16x16x32_bf16 v[40:43], v[196:199], a[68:71], v[40:43]
    ds_read_b128 v[188:191], v1 offset:30720
    v_and_b32 v89, 0xffff0000, v246
    v_mfma_f32_16x16x32_bf16 v[44:47], v[200:203], a[68:71], v[44:47]
    ds_read_b128 v[192:195], v1 offset:31744
    v_lshlrev_b32 v90, 16, v247
    s_waitcnt lgkmcnt(3)
    v_mfma_f32_16x16x32_bf16 v[48:51], v[204:207], a[68:71], v[48:51]
    ds_read_b128 v[196:199], v1 offset:40960
    v_and_b32 v91, 0xffff0000, v247
    v_mfma_f32_16x16x32_bf16 v[32:35], v[208:211], a[108:111], v[32:35]
    ds_read_b128 v[200:203], v1 offset:41984
    ds_read_b128 v[204:207], v1 offset:43008
    v_mfma_f32_16x16x32_bf16 v[36:39], v[180:183], a[108:111], v[36:39]
    s_waitcnt lgkmcnt(3)
    ds_read_b128 v[208:211], v1 offset:44032
    v_mfma_f32_16x16x32_bf16 v[40:43], v[184:187], a[108:111], v[40:43]
    v_mfma_f32_16x16x32_bf16 v[44:47], v[188:191], a[108:111], v[44:47]
    s_waitcnt vmcnt(0)
    s_barrier
    v_mfma_f32_16x16x32_bf16 v[48:51], v[192:195], a[108:111], v[48:51]
    ds_read_b128 v[180:183], v1 offset:45056
    ds_read_b128 v[184:187], v1 offset:46080
    s_waitcnt lgkmcnt(3)
    v_mfma_f32_16x16x32_bf16 v[32:35], v[196:199], a[112:115], v[32:35]
    ds_read_b128 v[188:191], v1 offset:47104
    ds_read_b128 v[192:195], v1 offset:48128
    v_mfma_f32_16x16x32_bf16 v[36:39], v[200:203], a[112:115], v[36:39]
    ds_read_b128 v[196:199], v1 offset:57344
    v_mfma_f32_16x16x32_bf16 v[40:43], v[204:207], a[112:115], v[40:43]
    s_waitcnt lgkmcnt(3)
    ds_read_b128 v[200:203], v1 offset:58368
    v_mfma_f32_16x16x32_bf16 v[44:47], v[208:211], a[112:115], v[44:47]
    ds_read_b128 v[204:207], v1 offset:59392
    ds_read_b128 v[208:211], v1 offset:60416
    v_mfma_f32_16x16x32_bf16 v[48:51], v[180:183], a[112:115], v[48:51]
    v_mfma_f32_16x16x32_bf16 v[32:35], v[184:187], a[116:119], v[32:35]
    s_waitcnt lgkmcnt(3)
    ds_read_b128 v[180:183], v1 offset:61440
    v_mfma_f32_16x16x32_bf16 v[36:39], v[188:191], a[116:119], v[36:39]
    ds_read_b128 v[184:187], v1 offset:62464
    ds_read_b128 v[188:191], v1 offset:63488
    v_mfma_f32_16x16x32_bf16 v[40:43], v[192:195], a[116:119], v[40:43]
    v_mfma_f32_16x16x32_bf16 v[44:47], v[196:199], a[116:119], v[44:47]
    s_waitcnt lgkmcnt(3)
    ds_read_b128 v[192:195], v1 offset:64512
    v_mfma_f32_16x16x32_bf16 v[48:51], v[200:203], a[116:119], v[48:51]
    ds_read_b128 v[196:199], v15 offset:8192
    ds_read_b128 v[200:203], v15 offset:9216
    v_mfma_f32_16x16x32_bf16 v[32:35], v[204:207], a[92:95], v[32:35]
    v_mfma_f32_16x16x32_bf16 v[36:39], v[208:211], a[92:95], v[36:39]
    s_waitcnt lgkmcnt(3)
    ds_read_b128 v[204:207], v15 offset:10240
    v_mfma_f32_16x16x32_bf16 v[40:43], v[180:183], a[92:95], v[40:43]
    ds_read_b128 v[208:211], v15 offset:11264
    ds_read_b128 v[180:183], v15 offset:12288
    v_mfma_f32_16x16x32_bf16 v[44:47], v[184:187], a[92:95], v[44:47]
    v_mfma_f32_16x16x32_bf16 v[48:51], v[188:191], a[92:95], v[48:51]
    s_waitcnt lgkmcnt(3)
    ds_read_b128 v[184:187], v15 offset:25600
    v_mfma_f32_16x16x32_bf16 v[32:35], v[192:195], a[96:99], v[32:35]
    ds_read_b128 v[188:191], v15 offset:30720
    ds_read_b128 v[192:195], v15 offset:44032
    v_mfma_f32_16x16x32_bf16 v[36:39], v[196:199], a[96:99], v[36:39]
    v_mfma_f32_16x16x32_bf16 v[40:43], v[200:203], a[96:99], v[40:43]
    s_waitcnt lgkmcnt(3)
    ds_read_b128 v[196:199], v15 offset:13312
    v_mfma_f32_16x16x32_bf16 v[44:47], v[204:207], a[96:99], v[44:47]
    ds_read_b128 v[200:203], v15 offset:26624
    ds_read_b128 v[204:207], v15 offset:31744
    v_mfma_f32_16x16x32_bf16 v[48:51], v[208:211], a[96:99], v[48:51]
    v_mfma_f32_16x16x32_bf16 v[32:35], v[180:183], a[100:103], v[32:35]
    s_waitcnt lgkmcnt(3)
    ds_read_b128 v[208:211], v15 offset:45056
    v_mfma_f32_16x16x32_bf16 v[32:35], v[184:187], a[104:107], v[32:35]
    ds_read_b128 v[180:183], v15 offset:14336
    ds_read_b128 v[184:187], v15 offset:27648
    v_mfma_f32_16x16x32_bf16 v[32:35], v[188:191], a[216:219], v[32:35]
    v_mfma_f32_16x16x32_bf16 v[32:35], v[192:195], a[224:227], v[32:35]
    s_waitcnt lgkmcnt(3)
    ds_read_b128 v[188:191], v15 offset:40960
    v_mfma_f32_16x16x32_bf16 v[36:39], v[196:199], a[100:103], v[36:39]
    ds_read_b128 v[192:195], v15 offset:46080
    ds_read_b128 v[196:199], v15 offset:15360
    v_mfma_f32_16x16x32_bf16 v[36:39], v[200:203], a[104:107], v[36:39]
    v_mfma_f32_16x16x32_bf16 v[36:39], v[204:207], a[216:219], v[36:39]
    s_nop 0
    v_cvt_pk_bf16_f32 v32, 0, v32
    s_waitcnt lgkmcnt(3)
    v_mfma_f32_16x16x32_bf16 v[36:39], v[208:211], a[224:227], v[36:39]
    ds_read_b128 v[200:203], v15 offset:28672
    v_cvt_pk_bf16_f32 v33, 0, v33
    v_mfma_f32_16x16x32_bf16 v[40:43], v[180:183], a[100:103], v[40:43]
    ds_read_b128 v[204:207], v15 offset:41984
    v_cvt_pk_bf16_f32 v34, 0, v34
    v_mfma_f32_16x16x32_bf16 v[40:43], v[184:187], a[104:107], v[40:43]
    v_cvt_pk_bf16_f32 v35, 0, v35
    v_mul_f32 v32, v32, v100
    ds_read_b128 v[208:211], v15 offset:47104
    v_mul_f32 v33, v33, v101
    v_mul_f32 v34, v34, v102
    v_mul_f32 v35, v35, v103
    s_waitcnt lgkmcnt(3)
    v_mfma_f32_16x16x32_bf16 v[40:43], v[188:191], a[216:219], v[40:43]
    ds_read_b128 v[180:183], v15 offset:24576
    v_cvt_pk_bf16_f32 v32, v32, v33
    v_mfma_f32_16x16x32_bf16 v[40:43], v[192:195], a[224:227], v[40:43]
    v_cvt_pk_bf16_f32 v33, v34, v35
    ds_write_b64 v5, v[32:33] offset:0
    v_mfma_f32_16x16x32_bf16 v[44:47], v[196:199], a[100:103], v[44:47]
    ds_read_b128 v[184:187], v15 offset:29696
    v_cvt_pk_bf16_f32 v36, 0, v36
    v_cvt_pk_bf16_f32 v37, 0, v37
    v_cvt_pk_bf16_f32 v38, 0, v38
    ds_read_b128 v[188:191], v15 offset:43008
    v_cvt_pk_bf16_f32 v39, 0, v39
    v_mul_f32 v36, v36, v112
    v_mul_f32 v37, v37, v113
    s_waitcnt lgkmcnt(4)
    v_mfma_f32_16x16x32_bf16 v[44:47], v[200:203], a[104:107], v[44:47]
    ds_read_b128 v[192:195], v15 offset:48128
    v_mul_f32 v38, v38, v114
    v_mfma_f32_16x16x32_bf16 v[44:47], v[204:207], a[216:219], v[44:47]
    v_mul_f32 v39, v39, v115
    v_cvt_pk_bf16_f32 v36, v36, v37
    v_mfma_f32_16x16x32_bf16 v[44:47], v[208:211], a[224:227], v[44:47]
    v_cvt_pk_bf16_f32 v37, v38, v39
    ds_write_b64 v5, v[36:37] offset:32
    v_cvt_pk_bf16_f32 v40, 0, v40
    v_cvt_pk_bf16_f32 v41, 0, v41
    v_cvt_pk_bf16_f32 v42, 0, v42
    v_cvt_pk_bf16_f32 v43, 0, v43
    s_waitcnt lgkmcnt(2)
    v_mfma_f32_16x16x32_bf16 v[48:51], v[180:183], a[100:103], v[48:51]
    v_mul_f32 v40, v40, v124
    v_mul_f32 v41, v41, v125
    v_mfma_f32_16x16x32_bf16 v[48:51], v[184:187], a[104:107], v[48:51]
    v_mul_f32 v42, v42, v126
    v_mul_f32 v43, v43, v127
    v_mfma_f32_16x16x32_bf16 v[48:51], v[188:191], a[216:219], v[48:51]
    v_cvt_pk_bf16_f32 v40, v40, v41
    v_cvt_pk_bf16_f32 v41, v42, v43
    ds_write_b64 v5, v[40:41] offset:64
    s_waitcnt lgkmcnt(2)
    v_mfma_f32_16x16x32_bf16 v[48:51], v[192:195], a[224:227], v[48:51]
    v_cvt_pk_bf16_f32 v44, 0, v44
    v_cvt_pk_bf16_f32 v45, 0, v45
    v_cvt_pk_bf16_f32 v46, 0, v46
    v_cvt_pk_bf16_f32 v47, 0, v47
    v_pk_mul_f32 v[44:45], v[44:45], v[136:137]
    v_pk_mul_f32 v[46:47], v[46:47], v[138:139]
    v_cvt_pk_bf16_f32 v44, v44, v45
    v_cvt_pk_bf16_f32 v45, v46, v47
    ds_write_b64 v5, v[44:45] offset:96
    v_cvt_pk_bf16_f32 v48, 0, v48
    v_cvt_pk_bf16_f32 v49, 0, v49
    v_cvt_pk_bf16_f32 v50, 0, v50
    v_cvt_pk_bf16_f32 v51, 0, v51
    v_pk_mul_f32 v[48:49], v[48:49], v[148:149]
    v_pk_mul_f32 v[50:51], v[50:51], v[150:151]
    v_cvt_pk_bf16_f32 v48, v48, v49
    v_cvt_pk_bf16_f32 v49, v50, v51
    ds_write_b64 v5, v[48:49] offset:128
    s_waitcnt lgkmcnt(0)
    ds_read_b128 v[180:183], v6 offset:0
    ds_read_b128 v[184:187], v6 offset:1024
    ds_read_b128 v[188:191], v6 offset:2048
    s_waitcnt lgkmcnt(2)
    v_lshlrev_b32 v60, 16, v180
    v_and_b32 v61, 0xffff0000, v180
    v_lshlrev_b32 v62, 16, v181
    v_and_b32 v63, 0xffff0000, v181
    v_lshlrev_b32 v64, 16, v182
    v_and_b32 v65, 0xffff0000, v182
    v_lshlrev_b32 v66, 16, v183
    v_and_b32 v67, 0xffff0000, v183
    v_pk_add_f32 v[52:53], v[52:53], v[60:61]
    v_pk_add_f32 v[54:55], v[54:55], v[62:63]
    v_pk_add_f32 v[56:57], v[56:57], v[64:65]
    v_pk_add_f32 v[58:59], v[58:59], v[66:67]
    v_cvt_pk_bf16_f32 v180, v52, v53
    v_cvt_pk_bf16_f32 v181, v54, v55
    v_cvt_pk_bf16_f32 v182, v56, v57
    v_cvt_pk_bf16_f32 v183, v58, v59
    buffer_store_dwordx4 v[180:183], v2, s[52:55], s76 offen
    s_waitcnt lgkmcnt(1)
    v_lshlrev_b32 v76, 16, v184
    v_and_b32 v77, 0xffff0000, v184
    v_lshlrev_b32 v78, 16, v185
    v_and_b32 v79, 0xffff0000, v185
    v_lshlrev_b32 v80, 16, v186
    v_and_b32 v81, 0xffff0000, v186
    v_lshlrev_b32 v82, 16, v187
    v_and_b32 v83, 0xffff0000, v187
    v_pk_add_f32 v[68:69], v[68:69], v[76:77]
    v_pk_add_f32 v[70:71], v[70:71], v[78:79]
    v_pk_add_f32 v[72:73], v[72:73], v[80:81]
    v_pk_add_f32 v[74:75], v[74:75], v[82:83]
    v_cvt_pk_bf16_f32 v184, v68, v69
    v_cvt_pk_bf16_f32 v185, v70, v71
    v_cvt_pk_bf16_f32 v186, v72, v73
    v_cvt_pk_bf16_f32 v187, v74, v75
    buffer_store_dwordx4 v[184:187], v3, s[52:55], s76 offen
    s_waitcnt lgkmcnt(0)
    v_lshlrev_b32 v92, 16, v188
    v_and_b32 v93, 0xffff0000, v188
    v_lshlrev_b32 v94, 16, v189
    v_and_b32 v95, 0xffff0000, v189
    v_lshlrev_b32 v96, 16, v190
    v_and_b32 v97, 0xffff0000, v190
    v_lshlrev_b32 v98, 16, v191
    v_and_b32 v99, 0xffff0000, v191
    v_pk_add_f32 v[84:85], v[84:85], v[92:93]
    v_pk_add_f32 v[86:87], v[86:87], v[94:95]
    v_pk_add_f32 v[88:89], v[88:89], v[96:97]
    v_pk_add_f32 v[90:91], v[90:91], v[98:99]
    v_cvt_pk_bf16_f32 v188, v84, v85
    v_cvt_pk_bf16_f32 v189, v86, v87
    v_cvt_pk_bf16_f32 v190, v88, v89
    v_cvt_pk_bf16_f32 v191, v90, v91
    buffer_store_dwordx4 v[188:191], v4, s[52:55], s76 offen
    s_or_b32 s12, s2, s4
    s_cbranch_scc1 L_nobump
    s_mov_b64 exec, 1
    buffer_store_dword v30, v31, s[48:51], 0 offen offset:0 sc0 sc1
    s_mov_b64 exec, -1
L_nobump:
L_end:
    s_endpgm
L_plp4:
    s_mov_b32 s77, 0
L_plp4r:
    buffer_load_dword v18, v217, s[48:51], 0 offen sc0 sc1
    s_add_u32 s77, s77, 1
    s_waitcnt vmcnt(0)
    v_cmp_ne_u32 vcc, s9, v18
    s_nop 1
    s_cbranch_vccz L_pok3
    s_cmp_lt_u32 s77, 0x4000
    s_cbranch_scc1 L_plp4r
    s_branch L_pok3
L_plp6:
    s_mov_b32 s77, 0
L_plp6r:
    buffer_load_dword v18, v218, s[48:51], 0 offen sc0 sc1
    s_add_u32 s77, s77, 1
    s_waitcnt vmcnt(0)
    v_cmp_ne_u32 vcc, s9, v18
    s_nop 1
    s_cbranch_vccz L_pok5
    s_cmp_lt_u32 s77, 0x4000
    s_cbranch_scc1 L_plp6r
    s_branch L_pok5
L_plp8:
    s_mov_b32 s77, 0
L_plp8r:
    buffer_load_dword v18, v219, s[48:51], 0 offen sc0 sc1
    s_add_u32 s77, s77, 1
    s_waitcnt vmcnt(0)
    v_cmp_ne_u32 vcc, s9, v18
    s_nop 1
    s_cbranch_vccz L_pok7
    s_cmp_lt_u32 s77, 0x4000
    s_cbranch_scc1 L_plp8r
    s_branch L_pok7
L_plp10:
    s_mov_b32 s77, 0
L_plp10r:
    buffer_load_dword v18, v220, s[48:51], 0 offen sc0 sc1
    s_add_u32 s77, s77, 1
    s_waitcnt vmcnt(0)
    v_cmp_ne_u32 vcc, s9, v18
    s_nop 1
    s_cbranch_vccz L_pok9
    s_cmp_lt_u32 s77, 0x4000
    s_cbranch_scc1 L_plp10r
    s_branch L_pok9
L_plp12:
    s_mov_b32 s77, 0
L_plp12r:
    buffer_load_dword v18, v221, s[48:51], 0 offen sc0 sc1
    s_add_u32 s77, s77, 1
    s_waitcnt vmcnt(0)
    v_cmp_ne_u32 vcc, s9, v18
    s_nop 1
    s_cbranch_vccz L_pok11
    s_cmp_lt_u32 s77, 0x4000
    s_cbranch_scc1 L_plp12r
    s_branch L_pok11
L_code_end:
.section .rodata,"a"
.p2align 6
.amdhsa_kernel recurrent_scan__sliding_local_dilated__glu_gated_reglu__prompt_kernel
  .amdhsa_next_free_vgpr 512
  .amdhsa_next_free_sgpr 102
  .amdhsa_accum_offset 256
  .amdhsa_group_segment_fixed_size 0
  .amdhsa_kernarg_size 80
  .amdhsa_user_sgpr_count 2
  .amdhsa_user_sgpr_kernarg_segment_ptr 1
  .amdhsa_system_sgpr_workgroup_id_x 1
  .amdhsa_float_denorm_mode_32 3
.end_amdhsa_kernel
```
